```python
import torch

def _softmax(x, axis=-1):
    return torch.softmax(x, dim=axis)
def _gelu(x):
    return torch.nn.functional.gelu(x, approximate="tanh")
def _silu(x):
    return torch.nn.functional.silu(x)
def _sigmoid(x):
    return torch.sigmoid(x)
def _layernorm(x, axis=-1, eps=1e-5):
    m = x.mean(dim=axis, keepdim=True)
    v = x.var(dim=axis, keepdim=True, unbiased=False)
    return (x - m) / torch.sqrt(v + eps)
def _scatter_add(tgt, idx, src, axis=0):
    return tgt.clone().index_add_(axis, idx, src)
def _segment_sum(src, seg, n):
    out = torch.zeros((n,) + src.shape[1:], dtype=src.dtype)
    return out.index_add_(0, seg, src)
def _pad(x, pw):
    flat = tuple(v for pair in reversed(pw) for v in pair)
    return torch.nn.functional.pad(x, flat)

kernel_name = 'gated_mix__ssm_conv_s4__glu_gated_bilinear__prompt'

def setup_inputs():

    _w = (lambda a: (lambda t: t.to(torch.bfloat16) if t.is_floating_point() else t)(torch.as_tensor(a)))
    def _A_setup():
        B, L, D, N = 1, 2048, 448, 256
        A_re = -(lambda _x: torch.exp(torch.as_tensor(_x)))((lambda *s: torch.randn(*s, dtype=torch.bfloat16) * 3.2)(D, N))
        A_im = torch.pi * (lambda *s: torch.randn(*s, dtype=torch.bfloat16) * 0.05)(D, N)
        B_re = (lambda *s: torch.randn(*s, dtype=torch.bfloat16) * 0.05)(D, N)
        B_im = (lambda *s: torch.randn(*s, dtype=torch.bfloat16) * 0.05)(D, N)
        C_re = (lambda *s: torch.randn(*s, dtype=torch.bfloat16) * 0.05)(D, N)
        C_im = (lambda *s: torch.randn(*s, dtype=torch.bfloat16) * 0.1)(D, N)
        log_dt = (lambda *s: torch.randn(*s, dtype=torch.bfloat16) * 0.05)(D) * 0.5 - 4.0
        Dskip = (lambda *s: torch.randn(*s, dtype=torch.bfloat16) * 0.05)(D)
        return {
            "u": _w((lambda *s: torch.randn(*s, dtype=torch.bfloat16) * 0.05)(B, L, D)),
            "A_re": _w(A_re),
            "A_im": _w(A_im),
            "B_re": _w(B_re),
            "B_im": _w(B_im),
            "C_re": _w(C_re),
            "C_im": _w(C_im),
            "log_dt": _w(log_dt),
            "Dskip": _w(Dskip),
        }
    _A_in = _A_setup()

    def _B_setup():
        B, S, D, F = 1, 2048, 448, 1792
        return {
            "x": _w((lambda *s: torch.randn(*s, dtype=torch.bfloat16) * 0.05)(B, S, D)),
            "w_gate": _w((lambda *s: torch.randn(*s, dtype=torch.bfloat16) * 0.8)(D, F) * (D ** -0.5)),
            "w_up": _w((lambda *s: torch.randn(*s, dtype=torch.bfloat16) * 0.8)(D, F) * (D ** -0.5)),
            "w_down": _w((lambda *s: torch.randn(*s, dtype=torch.bfloat16) * 0.8)(F, D) * (F ** -0.5)),
        }
    _B_in = _B_setup()

    return {
        "A_u": _A_in["u"],
        "A_A_re": _A_in["A_re"],
        "A_A_im": _A_in["A_im"],
        "A_B_re": _A_in["B_re"],
        "A_B_im": _A_in["B_im"],
        "A_C_re": _A_in["C_re"],
        "A_C_im": _A_in["C_im"],
        "A_log_dt": _A_in["log_dt"],
        "A_Dskip": _A_in["Dskip"],
        "B_x": _B_in["x"],
        "B_w_gate": _B_in["w_gate"],
        "B_w_up": _B_in["w_up"],
        "B_w_down": _B_in["w_down"],
        "gate_w": _w((lambda *s: torch.randn(*s, dtype=torch.bfloat16) * 0.05)(448) * 16.0),
    }

def reference(A_u, A_A_re, A_A_im, A_B_re, A_B_im, A_C_re, A_C_im, A_log_dt, A_Dskip, B_x, B_w_gate, B_w_up, B_w_down, gate_w):
    def _A_ref(u, A_re, A_im, B_re, B_im, C_re, C_im, log_dt, Dskip):
        Bsz, L, D = u.shape
        dt = torch.exp(log_dt)[:, None]
        A = A_re + 1j * A_im
        Bc = B_re + 1j * B_im
        Cc = C_re + 1j * C_im
        logdA = dt * A
        dB = dt * Bc
        l = (lambda x, dt: x.to(dt))(torch.arange(L), A_re.dtype)
        P = torch.exp(logdA[:, :, None] * l[None, None, :])
        K = torch.einsum("dn,dnl,dn->dl", Cc, P, dB).real
        L2 = 2 * L
        Kp = _pad(K, ((0, 0), (0, L)))
        up = (lambda x, *d: x.permute(*d))(u, 0, 2, 1)
        up = _pad(up, ((0, 0), (0, 0), (0, L)))
        Kf = (lambda x, axes=(-2,-1): torch.fft.rfft2(x.float(), dim=axes))(Kp[:, None, :], axes=(-2, -1))
        Uf = (lambda x, axes=(-2,-1): torch.fft.rfft2(x.float(), dim=axes))(up[:, :, None, :], axes=(-2, -1))
        Yf = Uf * Kf[None, :, :, :]
        y = (lambda x, s, axes=(-2,-1): torch.fft.irfft2(x, s=s, dim=axes).to(torch.bfloat16))(Yf, (1, L2), axes=(-2, -1))[:, :, 0, :L]
        y = (lambda x, *d: x.permute(*d))(y, 0, 2, 1) + u * Dskip[None, None, :]
        return y

    def _B_ref(x, w_gate, w_up, w_down):
        g = torch.einsum("bsd,df->bsf", x, w_gate)
        u = torch.einsum("bsd,df->bsf", x, w_up)
        h = g * u
        return torch.einsum("bsf,fd->bsd", h, w_down)

    x = A_u
    g = _sigmoid((x * gate_w).sum(-1, keepdims=True))
    a = _A_ref(x, A_A_re, A_A_im, A_B_re, A_B_im, A_C_re, A_C_im, A_log_dt, A_Dskip)
    b = _B_ref(x, B_w_gate, B_w_up, B_w_down)
    return g * a + (1 - g) * b
```

```asm
; @launch grid=(512,1,1) block=(256,1,1) lds=81920
.amdgcn_target "amdgcn-amd-amdhsa--gfx950"
.text
.globl gated_mix__ssm_conv_s4__glu_gated_bilinear__prompt_kernel
.p2align 8
.type gated_mix__ssm_conv_s4__glu_gated_bilinear__prompt_kernel,@function
gated_mix__ssm_conv_s4__glu_gated_bilinear__prompt_kernel:
    s_cmp_lt_u32 s2, 224
    s_cbranch_scc1 L_g
    s_cmp_lt_u32 s2, 256
    s_cbranch_scc1 L_gate
    s_cmp_lt_u32 s2, 480
    s_cbranch_scc1 L_s
    s_cmp_lt_u32 s2, 508
    s_cbranch_scc1 L_p2
L_exit:
    s_endpgm
L_g:
    s_setprio 1
    s_load_dwordx4 s[44:47], s[0:1], 112
    s_load_dwordx2 s[4:5], s[0:1], 0
    s_load_dwordx4 s[8:11], s[0:1], 80
    s_load_dwordx2 s[16:17], s[0:1], 128
    v_lshrrev_b32 v1, 6, v0
    v_and_b32 v2, 63, v0
    s_mov_b32 s19, s2
    v_readfirstlane_b32 s25, v1
    v_lshrrev_b32 v14, 4, v2
    v_bfe_u32 v15, v2, 2, 2
    v_and_b32 v16, 3, v2
    v_lshrrev_b32 v17, 3, v2
    v_mul_u32_u24 v18, 896, v17
    v_and_b32 v19, 7, v2
    v_xor_b32 v20, v19, v14
    v_lshl_add_u32 v5, v20, 4, v18
    v_or_b32 v20, 4, v14
    v_xor_b32 v20, v19, v20
    v_lshl_add_u32 v21, v20, 4, v18
    v_add_u32 v22, 12288, v5
    v_add_u32 v23, 18432, v21
    v_add_u32 v21, 6144, v21
    v_xor_b32 v17, v15, v14
    v_lshlrev_b32 v17, 6, v17
    v_lshl_add_u32 v17, v16, 4, v17
    v_mul_u32_u24 v18, 3584, v14
    v_add_u32 v3, v17, v18
    v_add_u32 v4, 13312, v3
    s_and_b32 s20, s19, 7
    s_lshr_b32 s21, s19, 3
    s_and_b32 s22, s20, 1
    s_lshr_b32 s23, s20, 1
    s_mul_i32 s23, s23, 28
    s_add_u32 s23, s23, s21
    s_lshr_b32 s24, s23, 3
    s_and_b32 s23, s23, 7
    s_lshl_b32 s22, s22, 3
    s_add_u32 s23, s23, s22
    s_mul_i32 s30, s25, 28672
    s_lshl_b32 s28, s24, 8
    s_add_u32 s30, s30, s28
    s_lshl_b32 s31, s23, 7
    s_lshl_b32 s28, s25, 5
    s_add_u32 s31, s31, s28
    s_mul_i32 s31, s31, 896
    s_lshl_b32 s32, s25, 11
    s_add_u32 s32, s32, 32768
    s_lshl_b32 s33, s25, 12
    s_mov_b32 s6, 1835008
    s_mov_b32 s7, 0x20000
    s_mov_b32 s14, 1605632
    s_mov_b32 s15, 0x20000
    s_mov_b32 m0, s33
    s_waitcnt lgkmcnt(0)
    s_mov_b32 s12, s10
    s_mov_b32 s13, s11
    s_mov_b32 s10, 1605632
    s_mov_b32 s11, 0x20000
    s_lshr_b32 s34, s21, 3
    s_add_u32 s34, s34, s21
    s_mul_i32 s28, s34, 9363
    s_lshr_b32 s28, s28, 16
    s_mul_i32 s28, s28, 7
    s_sub_u32 s34, s34, s28
    s_mul_i32 s34, s34, 1
    s_mul_i32 s28, s34, 9363
    s_lshr_b32 s28, s28, 16
    s_mul_i32 s28, s28, 7
    s_sub_u32 s34, s34, s28
    s_mul_i32 s28, s34, 229376
    s_add_u32 s62, s30, 1605632
    s_add_u32 s30, s30, s28
    s_add_u32 s63, s31, 896
    s_lshl_b32 s28, s34, 7
    s_add_u32 s31, s31, s28
    buffer_load_dwordx4 v5, s[4:7], s31 offen offset:0 lds
    buffer_load_dwordx4 v21, s[4:7], s31 offen offset:1024 lds
    buffer_load_dwordx4 v22, s[4:7], s31 offen offset:2048 lds
    buffer_load_dwordx4 v23, s[4:7], s31 offen offset:3072 lds
    s_add_u32 s31, s31, 128
    s_cmp_eq_u32 s31, s63
    s_cselect_b32 s28, 896, 0
    s_sub_u32 s31, s31, s28
    s_add_u32 m0, s32, 0
    s_nop 0
    buffer_load_dwordx4 v3, s[8:11], s30 offen offset:0 lds
    buffer_load_dwordx4 v4, s[8:11], s30 offen offset:1024 lds
    s_add_u32 m0, m0, 8192
    s_nop 0
    buffer_load_dwordx4 v3, s[12:15], s30 offen offset:0 lds
    buffer_load_dwordx4 v4, s[12:15], s30 offen offset:1024 lds
    s_add_u32 s30, s30, 114688
    s_cmp_eq_u32 s30, s62
    s_cselect_b32 s28, 1605632, 0
    s_sub_u32 s30, s30, s28
    s_add_u32 m0, s32, 16384
    s_nop 0
    buffer_load_dwordx4 v3, s[8:11], s30 offen offset:0 lds
    buffer_load_dwordx4 v4, s[8:11], s30 offen offset:1024 lds
    s_add_u32 m0, m0, 8192
    s_nop 0
    buffer_load_dwordx4 v3, s[12:15], s30 offen offset:0 lds
    buffer_load_dwordx4 v4, s[12:15], s30 offen offset:1024 lds
    s_add_u32 s30, s30, 114688
    s_cmp_eq_u32 s30, s62
    s_cselect_b32 s28, 1605632, 0
    s_sub_u32 s30, s30, s28
    s_cmp_lg_u32 s2, 0
    s_cbranch_scc1 L_g_nononce
    s_memrealtime s[48:49]
    s_waitcnt lgkmcnt(0)
    s_or_b32 s48, s48, 1
    v_mov_b32 v14, 0
    v_mov_b32 v15, s48
    v_cmp_eq_u32 vcc, 0, v0
    s_nop 3
    s_and_saveexec_b64 s[56:57], vcc
    s_cbranch_execz L_g_nononce2
    global_store_dword v14, v15, s[46:47] sc0 sc1
L_g_nononce2:
    s_mov_b64 exec, s[56:57]
L_g_nononce:
    s_mov_b32 s18, 7340032
    s_mov_b32 s19, 0x20000
    s_add_u32 s48, s16, 8388608
    s_addc_u32 s49, s17, 0
    s_mov_b32 s50, 1605632
    s_mov_b32 s51, 0x20000
    s_add_u32 s52, s16, 10092544
    s_addc_u32 s53, s17, 0
    v_lshrrev_b32 v14, 4, v2
    v_bfe_u32 v15, v2, 2, 2
    v_and_b32 v16, 3, v2
    s_and_b32 s26, s25, 1
    s_lshr_b32 s27, s25, 1
    v_lshrrev_b32 v17, 5, v2
    v_lshl_add_u32 v18, v17, 3, v15
    v_lshlrev_b32 v18, 8, v18
    v_and_b32 v19, 1, v14
    v_lshl_add_u32 v18, v19, 5, v18
    v_lshl_add_u32 v18, v16, 3, v18
    v_add_u32 v18, 32768, v18
    s_lshl_b32 s28, s26, 1
    v_xor_b32 v19, s28, v15
    v_lshl_add_u32 v6, v19, 6, v18
    s_add_u32 s28, s28, 1
    v_xor_b32 v19, s28, v15
    v_lshl_add_u32 v7, v19, 6, v18
    v_mov_b32 v8, v6
    v_mov_b32 v9, v7
    v_and_b32 v18, 31, v2
    v_bfe_u32 v19, v18, 1, 3
    s_lshl_b32 s28, s27, 6
    v_add_u32 v18, s28, v18
    v_lshlrev_b32 v18, 7, v18
    v_add_u32 v20, 0, v17
    v_xor_b32 v20, v20, v19
    v_lshl_add_u32 v10, v20, 4, v18
    v_add_u32 v20, 2, v17
    v_xor_b32 v20, v20, v19
    v_lshl_add_u32 v11, v20, 4, v18
    v_add_u32 v20, 4, v17
    v_xor_b32 v20, v20, v19
    v_lshl_add_u32 v12, v20, 4, v18
    v_add_u32 v20, 6, v17
    v_xor_b32 v20, v20, v19
    v_lshl_add_u32 v13, v20, 4, v18
    v_mov_b32 v128, 0
    v_mov_b32 v129, 0
    v_mov_b32 v130, 0
    v_mov_b32 v131, 0
    v_mov_b32 v132, 0
    v_mov_b32 v133, 0
    v_mov_b32 v134, 0
    v_mov_b32 v135, 0
    v_mov_b32 v136, 0
    v_mov_b32 v137, 0
    v_mov_b32 v138, 0
    v_mov_b32 v139, 0
    v_mov_b32 v140, 0
    v_mov_b32 v141, 0
    v_mov_b32 v142, 0
    v_mov_b32 v143, 0
    v_mov_b32 v144, 0
    v_mov_b32 v145, 0
    v_mov_b32 v146, 0
    v_mov_b32 v147, 0
    v_mov_b32 v148, 0
    v_mov_b32 v149, 0
    v_mov_b32 v150, 0
    v_mov_b32 v151, 0
    v_mov_b32 v152, 0
    v_mov_b32 v153, 0
    v_mov_b32 v154, 0
    v_mov_b32 v155, 0
    v_mov_b32 v156, 0
    v_mov_b32 v157, 0
    v_mov_b32 v158, 0
    v_mov_b32 v159, 0
    v_mov_b32 v160, 0
    v_mov_b32 v161, 0
    v_mov_b32 v162, 0
    v_mov_b32 v163, 0
    v_mov_b32 v164, 0
    v_mov_b32 v165, 0
    v_mov_b32 v166, 0
    v_mov_b32 v167, 0
    v_mov_b32 v168, 0
    v_mov_b32 v169, 0
    v_mov_b32 v170, 0
    v_mov_b32 v171, 0
    v_mov_b32 v172, 0
    v_mov_b32 v173, 0
    v_mov_b32 v174, 0
    v_mov_b32 v175, 0
    v_mov_b32 v176, 0
    v_mov_b32 v177, 0
    v_mov_b32 v178, 0
    v_mov_b32 v179, 0
    v_mov_b32 v180, 0
    v_mov_b32 v181, 0
    v_mov_b32 v182, 0
    v_mov_b32 v183, 0
    v_mov_b32 v184, 0
    v_mov_b32 v185, 0
    v_mov_b32 v186, 0
    v_mov_b32 v187, 0
    v_mov_b32 v188, 0
    v_mov_b32 v189, 0
    v_mov_b32 v190, 0
    v_mov_b32 v191, 0
    v_mov_b32 v192, 0
    v_mov_b32 v193, 0
    v_mov_b32 v194, 0
    v_mov_b32 v195, 0
    v_mov_b32 v196, 0
    v_mov_b32 v197, 0
    v_mov_b32 v198, 0
    v_mov_b32 v199, 0
    v_mov_b32 v200, 0
    v_mov_b32 v201, 0
    v_mov_b32 v202, 0
    v_mov_b32 v203, 0
    v_mov_b32 v204, 0
    v_mov_b32 v205, 0
    v_mov_b32 v206, 0
    v_mov_b32 v207, 0
    v_mov_b32 v208, 0
    v_mov_b32 v209, 0
    v_mov_b32 v210, 0
    v_mov_b32 v211, 0
    v_mov_b32 v212, 0
    v_mov_b32 v213, 0
    v_mov_b32 v214, 0
    v_mov_b32 v215, 0
    v_mov_b32 v216, 0
    v_mov_b32 v217, 0
    v_mov_b32 v218, 0
    v_mov_b32 v219, 0
    v_mov_b32 v220, 0
    v_mov_b32 v221, 0
    v_mov_b32 v222, 0
    v_mov_b32 v223, 0
    v_mov_b32 v224, 0
    v_mov_b32 v225, 0
    v_mov_b32 v226, 0
    v_mov_b32 v227, 0
    v_mov_b32 v228, 0
    v_mov_b32 v229, 0
    v_mov_b32 v230, 0
    v_mov_b32 v231, 0
    v_mov_b32 v232, 0
    v_mov_b32 v233, 0
    v_mov_b32 v234, 0
    v_mov_b32 v235, 0
    v_mov_b32 v236, 0
    v_mov_b32 v237, 0
    v_mov_b32 v238, 0
    v_mov_b32 v239, 0
    v_mov_b32 v240, 0
    v_mov_b32 v241, 0
    v_mov_b32 v242, 0
    v_mov_b32 v243, 0
    v_mov_b32 v244, 0
    v_mov_b32 v245, 0
    v_mov_b32 v246, 0
    v_mov_b32 v247, 0
    v_mov_b32 v248, 0
    v_mov_b32 v249, 0
    v_mov_b32 v250, 0
    v_mov_b32 v251, 0
    v_mov_b32 v252, 0
    v_mov_b32 v253, 0
    v_mov_b32 v254, 0
    v_mov_b32 v255, 0
    s_mov_b32 s41, 0
    s_mov_b32 s36, 32768
    s_mov_b32 s37, 16384
    s_waitcnt vmcnt(4) lgkmcnt(0)
    s_barrier
    ds_read_b128 v[48:51], v10 offset:0
    ds_read_b128 v[52:55], v10 offset:4096
    ds_read_b64_tr_b16 v[32:33], v8 offset:0
    ds_read_b64_tr_b16 v[34:35], v8 offset:1024
    ds_read_b64_tr_b16 v[36:37], v9 offset:0
    ds_read_b64_tr_b16 v[38:39], v9 offset:1024
    ds_read_b64_tr_b16 v[40:41], v8 offset:8192
    ds_read_b64_tr_b16 v[42:43], v8 offset:9216
    ds_read_b64_tr_b16 v[44:45], v9 offset:8192
    ds_read_b64_tr_b16 v[46:47], v9 offset:9216
    s_add_u32 m0, s33, s37
    s_nop 0
    buffer_load_dwordx4 v5, s[4:7], s31 offen offset:0 lds
    buffer_load_dwordx4 v21, s[4:7], s31 offen offset:1024 lds
    buffer_load_dwordx4 v22, s[4:7], s31 offen offset:2048 lds
    buffer_load_dwordx4 v23, s[4:7], s31 offen offset:3072 lds
    s_add_u32 s31, s31, 128
    s_cmp_eq_u32 s31, s63
    s_cselect_b32 s28, 896, 0
    s_sub_u32 s31, s31, s28
    s_waitcnt lgkmcnt(0)
    v_mfma_f32_32x32x16_bf16 v[128:143], v[32:35], v[48:51], v[128:143]
    ds_read_b128 v[72:75], v11 offset:0
    ds_read_b128 v[76:79], v11 offset:4096
    ds_read_b64_tr_b16 v[56:57], v8 offset:4096
    v_mfma_f32_32x32x16_bf16 v[144:159], v[32:35], v[52:55], v[144:159]
    ds_read_b64_tr_b16 v[58:59], v8 offset:5120
    ds_read_b64_tr_b16 v[60:61], v9 offset:4096
    ds_read_b64_tr_b16 v[62:63], v9 offset:5120
    v_mfma_f32_32x32x16_bf16 v[160:175], v[36:39], v[48:51], v[160:175]
    ds_read_b64_tr_b16 v[64:65], v8 offset:12288
    ds_read_b64_tr_b16 v[66:67], v8 offset:13312
    v_mfma_f32_32x32x16_bf16 v[176:191], v[36:39], v[52:55], v[176:191]
    ds_read_b64_tr_b16 v[68:69], v9 offset:12288
    ds_read_b64_tr_b16 v[70:71], v9 offset:13312
    v_mfma_f32_32x32x16_bf16 v[192:207], v[40:43], v[48:51], v[192:207]
    s_add_u32 m0, s32, s36
    s_nop 0
    buffer_load_dwordx4 v3, s[8:11], s30 offen offset:0 lds
    s_mov_b32 s36, s41
    s_add_u32 s41, s41, 16384
    v_mfma_f32_32x32x16_bf16 v[208:223], v[40:43], v[52:55], v[208:223]
    buffer_load_dwordx4 v4, s[8:11], s30 offen offset:1024 lds
    s_cmp_eq_u32 s41, 49152
    s_cselect_b32 s41, 0, s41
    v_mfma_f32_32x32x16_bf16 v[224:239], v[44:47], v[48:51], v[224:239]
    s_add_u32 m0, m0, 8192
    s_nop 0
    buffer_load_dwordx4 v3, s[12:15], s30 offen offset:0 lds
    v_add_u32 v8, s41, v6
    v_add_u32 v9, s41, v7
    v_mfma_f32_32x32x16_bf16 v[240:255], v[44:47], v[52:55], v[240:255]
    buffer_load_dwordx4 v4, s[12:15], s30 offen offset:1024 lds
    s_add_u32 s30, s30, 114688
    s_cmp_eq_u32 s30, s62
    s_cselect_b32 s28, 1605632, 0
    s_sub_u32 s30, s30, s28
    s_waitcnt vmcnt(8) lgkmcnt(0)
    s_barrier
    v_mfma_f32_32x32x16_bf16 v[128:143], v[56:59], v[72:75], v[128:143]
    ds_read_b128 v[48:51], v12 offset:0
    ds_read_b128 v[52:55], v12 offset:4096
    ds_read_b64_tr_b16 v[32:33], v8 offset:0
    v_mfma_f32_32x32x16_bf16 v[144:159], v[56:59], v[76:79], v[144:159]
    ds_read_b64_tr_b16 v[34:35], v8 offset:1024
    ds_read_b64_tr_b16 v[36:37], v9 offset:0
    ds_read_b64_tr_b16 v[38:39], v9 offset:1024
    v_mfma_f32_32x32x16_bf16 v[160:175], v[60:63], v[72:75], v[160:175]
    ds_read_b64_tr_b16 v[40:41], v8 offset:8192
    ds_read_b64_tr_b16 v[42:43], v8 offset:9216
    v_mfma_f32_32x32x16_bf16 v[176:191], v[60:63], v[76:79], v[176:191]
    ds_read_b64_tr_b16 v[44:45], v9 offset:8192
    ds_read_b64_tr_b16 v[46:47], v9 offset:9216
    v_mfma_f32_32x32x16_bf16 v[192:207], v[64:67], v[72:75], v[192:207]
    s_add_u32 m0, s32, s36
    s_nop 0
    buffer_load_dwordx4 v3, s[8:11], s30 offen offset:0 lds
    v_mfma_f32_32x32x16_bf16 v[208:223], v[64:67], v[76:79], v[208:223]
    v_mfma_f32_32x32x16_bf16 v[224:239], v[68:71], v[72:75], v[224:239]
    buffer_load_dwordx4 v4, s[8:11], s30 offen offset:1024 lds
    v_mfma_f32_32x32x16_bf16 v[240:255], v[68:71], v[76:79], v[240:255]
    s_waitcnt lgkmcnt(0)
    v_mfma_f32_32x32x16_bf16 v[128:143], v[32:35], v[48:51], v[128:143]
    ds_read_b128 v[72:75], v13 offset:0
    ds_read_b128 v[76:79], v13 offset:4096
    ds_read_b64_tr_b16 v[56:57], v8 offset:4096
    v_mfma_f32_32x32x16_bf16 v[144:159], v[32:35], v[52:55], v[144:159]
    ds_read_b64_tr_b16 v[58:59], v8 offset:5120
    ds_read_b64_tr_b16 v[60:61], v9 offset:4096
    ds_read_b64_tr_b16 v[62:63], v9 offset:5120
    v_mfma_f32_32x32x16_bf16 v[160:175], v[36:39], v[48:51], v[160:175]
    ds_read_b64_tr_b16 v[64:65], v8 offset:12288
    ds_read_b64_tr_b16 v[66:67], v8 offset:13312
    v_mfma_f32_32x32x16_bf16 v[176:191], v[36:39], v[52:55], v[176:191]
    ds_read_b64_tr_b16 v[68:69], v9 offset:12288
    ds_read_b64_tr_b16 v[70:71], v9 offset:13312
    v_mfma_f32_32x32x16_bf16 v[192:207], v[40:43], v[48:51], v[192:207]
    s_add_u32 m0, m0, 8192
    s_nop 0
    buffer_load_dwordx4 v3, s[12:15], s30 offen offset:0 lds
    s_mov_b32 s36, s41
    s_add_u32 s41, s41, 16384
    s_cmp_eq_u32 s41, 49152
    v_mfma_f32_32x32x16_bf16 v[208:223], v[40:43], v[52:55], v[208:223]
    s_cselect_b32 s41, 0, s41
    v_add_u32 v8, s41, v6
    v_add_u32 v9, s41, v7
    v_mfma_f32_32x32x16_bf16 v[224:239], v[44:47], v[48:51], v[224:239]
    buffer_load_dwordx4 v4, s[12:15], s30 offen offset:1024 lds
    s_add_u32 s30, s30, 114688
    s_cmp_eq_u32 s30, s62
    s_cselect_b32 s28, 1605632, 0
    s_sub_u32 s30, s30, s28
    v_xor_b32 v10, 16384, v10
    v_xor_b32 v11, 16384, v11
    v_xor_b32 v12, 16384, v12
    v_mfma_f32_32x32x16_bf16 v[240:255], v[44:47], v[52:55], v[240:255]
    v_xor_b32 v13, 16384, v13
    s_xor_b32 s37, s37, 16384
    v_mov_b32 v24, 0
    v_min_u32 v25, 27, v2
    v_lshlrev_b32 v25, 2, v25
    v_add_u32 v25, 2048, v25
    s_mov_b32 s42, 5
L_g1_loop:
    s_waitcnt vmcnt(4) lgkmcnt(0)
    s_barrier
    s_cmp_eq_u32 s42, 1
    s_cbranch_scc0 L_g_noearly
    global_load_dword v26, v24, s[46:47] sc1
    global_load_dword v27, v25, s[52:53] sc1
L_g_noearly:
    v_mfma_f32_32x32x16_bf16 v[128:143], v[56:59], v[72:75], v[128:143]
    ds_read_b128 v[48:51], v10 offset:0
    ds_read_b128 v[52:55], v10 offset:4096
    ds_read_b64_tr_b16 v[32:33], v8 offset:0
    v_mfma_f32_32x32x16_bf16 v[144:159], v[56:59], v[76:79], v[144:159]
    ds_read_b64_tr_b16 v[34:35], v8 offset:1024
    ds_read_b64_tr_b16 v[36:37], v9 offset:0
    ds_read_b64_tr_b16 v[38:39], v9 offset:1024
    v_mfma_f32_32x32x16_bf16 v[160:175], v[60:63], v[72:75], v[160:175]
    ds_read_b64_tr_b16 v[40:41], v8 offset:8192
    ds_read_b64_tr_b16 v[42:43], v8 offset:9216
    v_mfma_f32_32x32x16_bf16 v[176:191], v[60:63], v[76:79], v[176:191]
    ds_read_b64_tr_b16 v[44:45], v9 offset:8192
    ds_read_b64_tr_b16 v[46:47], v9 offset:9216
    v_mfma_f32_32x32x16_bf16 v[192:207], v[64:67], v[72:75], v[192:207]
    s_add_u32 m0, s33, s37
    s_nop 0
    buffer_load_dwordx4 v5, s[4:7], s31 offen offset:0 lds
    v_mfma_f32_32x32x16_bf16 v[208:223], v[64:67], v[76:79], v[208:223]
    buffer_load_dwordx4 v21, s[4:7], s31 offen offset:1024 lds
    v_mfma_f32_32x32x16_bf16 v[224:239], v[68:71], v[72:75], v[224:239]
    buffer_load_dwordx4 v22, s[4:7], s31 offen offset:2048 lds
    v_mfma_f32_32x32x16_bf16 v[240:255], v[68:71], v[76:79], v[240:255]
    buffer_load_dwordx4 v23, s[4:7], s31 offen offset:3072 lds
    s_add_u32 s31, s31, 128
    s_cmp_eq_u32 s31, s63
    s_cselect_b32 s28, 896, 0
    s_sub_u32 s31, s31, s28
    s_waitcnt lgkmcnt(0)
    v_mfma_f32_32x32x16_bf16 v[128:143], v[32:35], v[48:51], v[128:143]
    ds_read_b128 v[72:75], v11 offset:0
    ds_read_b128 v[76:79], v11 offset:4096
    ds_read_b64_tr_b16 v[56:57], v8 offset:4096
    v_mfma_f32_32x32x16_bf16 v[144:159], v[32:35], v[52:55], v[144:159]
    ds_read_b64_tr_b16 v[58:59], v8 offset:5120
    ds_read_b64_tr_b16 v[60:61], v9 offset:4096
    ds_read_b64_tr_b16 v[62:63], v9 offset:5120
    v_mfma_f32_32x32x16_bf16 v[160:175], v[36:39], v[48:51], v[160:175]
    ds_read_b64_tr_b16 v[64:65], v8 offset:12288
    ds_read_b64_tr_b16 v[66:67], v8 offset:13312
    v_mfma_f32_32x32x16_bf16 v[176:191], v[36:39], v[52:55], v[176:191]
    ds_read_b64_tr_b16 v[68:69], v9 offset:12288
    ds_read_b64_tr_b16 v[70:71], v9 offset:13312
    v_mfma_f32_32x32x16_bf16 v[192:207], v[40:43], v[48:51], v[192:207]
    s_add_u32 m0, s32, s36
    s_nop 0
    buffer_load_dwordx4 v3, s[8:11], s30 offen offset:0 lds
    s_mov_b32 s36, s41
    s_add_u32 s41, s41, 16384
    v_mfma_f32_32x32x16_bf16 v[208:223], v[40:43], v[52:55], v[208:223]
    buffer_load_dwordx4 v4, s[8:11], s30 offen offset:1024 lds
    s_cmp_eq_u32 s41, 49152
    s_cselect_b32 s41, 0, s41
    v_mfma_f32_32x32x16_bf16 v[224:239], v[44:47], v[48:51], v[224:239]
    s_add_u32 m0, m0, 8192
    s_nop 0
    buffer_load_dwordx4 v3, s[12:15], s30 offen offset:0 lds
    v_add_u32 v8, s41, v6
    v_add_u32 v9, s41, v7
    v_mfma_f32_32x32x16_bf16 v[240:255], v[44:47], v[52:55], v[240:255]
    buffer_load_dwordx4 v4, s[12:15], s30 offen offset:1024 lds
    s_add_u32 s30, s30, 114688
    s_cmp_eq_u32 s30, s62
    s_cselect_b32 s28, 1605632, 0
    s_sub_u32 s30, s30, s28
    s_waitcnt vmcnt(8) lgkmcnt(0)
    s_barrier
    v_mfma_f32_32x32x16_bf16 v[128:143], v[56:59], v[72:75], v[128:143]
    ds_read_b128 v[48:51], v12 offset:0
    ds_read_b128 v[52:55], v12 offset:4096
    ds_read_b64_tr_b16 v[32:33], v8 offset:0
    v_mfma_f32_32x32x16_bf16 v[144:159], v[56:59], v[76:79], v[144:159]
    ds_read_b64_tr_b16 v[34:35], v8 offset:1024
    ds_read_b64_tr_b16 v[36:37], v9 offset:0
    ds_read_b64_tr_b16 v[38:39], v9 offset:1024
    v_mfma_f32_32x32x16_bf16 v[160:175], v[60:63], v[72:75], v[160:175]
    ds_read_b64_tr_b16 v[40:41], v8 offset:8192
    ds_read_b64_tr_b16 v[42:43], v8 offset:9216
    v_mfma_f32_32x32x16_bf16 v[176:191], v[60:63], v[76:79], v[176:191]
    ds_read_b64_tr_b16 v[44:45], v9 offset:8192
    ds_read_b64_tr_b16 v[46:47], v9 offset:9216
    v_mfma_f32_32x32x16_bf16 v[192:207], v[64:67], v[72:75], v[192:207]
    s_add_u32 m0, s32, s36
    s_nop 0
    buffer_load_dwordx4 v3, s[8:11], s30 offen offset:0 lds
    v_mfma_f32_32x32x16_bf16 v[208:223], v[64:67], v[76:79], v[208:223]
    v_mfma_f32_32x32x16_bf16 v[224:239], v[68:71], v[72:75], v[224:239]
    buffer_load_dwordx4 v4, s[8:11], s30 offen offset:1024 lds
    v_mfma_f32_32x32x16_bf16 v[240:255], v[68:71], v[76:79], v[240:255]
    s_waitcnt lgkmcnt(0)
    v_mfma_f32_32x32x16_bf16 v[128:143], v[32:35], v[48:51], v[128:143]
    ds_read_b128 v[72:75], v13 offset:0
    ds_read_b128 v[76:79], v13 offset:4096
    ds_read_b64_tr_b16 v[56:57], v8 offset:4096
    v_mfma_f32_32x32x16_bf16 v[144:159], v[32:35], v[52:55], v[144:159]
    ds_read_b64_tr_b16 v[58:59], v8 offset:5120
    ds_read_b64_tr_b16 v[60:61], v9 offset:4096
    ds_read_b64_tr_b16 v[62:63], v9 offset:5120
    v_mfma_f32_32x32x16_bf16 v[160:175], v[36:39], v[48:51], v[160:175]
    ds_read_b64_tr_b16 v[64:65], v8 offset:12288
    ds_read_b64_tr_b16 v[66:67], v8 offset:13312
    v_mfma_f32_32x32x16_bf16 v[176:191], v[36:39], v[52:55], v[176:191]
    ds_read_b64_tr_b16 v[68:69], v9 offset:12288
    ds_read_b64_tr_b16 v[70:71], v9 offset:13312
    v_mfma_f32_32x32x16_bf16 v[192:207], v[40:43], v[48:51], v[192:207]
    s_add_u32 m0, m0, 8192
    s_nop 0
    buffer_load_dwordx4 v3, s[12:15], s30 offen offset:0 lds
    s_mov_b32 s36, s41
    s_add_u32 s41, s41, 16384
    s_cmp_eq_u32 s41, 49152
    s_cselect_b32 s41, 0, s41
    v_mfma_f32_32x32x16_bf16 v[208:223], v[40:43], v[52:55], v[208:223]
    v_add_u32 v8, s41, v6
    v_add_u32 v9, s41, v7
    v_xor_b32 v10, 16384, v10
    v_xor_b32 v11, 16384, v11
    v_mfma_f32_32x32x16_bf16 v[224:239], v[44:47], v[48:51], v[224:239]
    buffer_load_dwordx4 v4, s[12:15], s30 offen offset:1024 lds
    s_add_u32 s30, s30, 114688
    s_cmp_eq_u32 s30, s62
    s_cselect_b32 s28, 1605632, 0
    s_sub_u32 s30, s30, s28
    v_xor_b32 v12, 16384, v12
    v_xor_b32 v13, 16384, v13
    s_xor_b32 s37, s37, 16384
    s_sub_u32 s42, s42, 1
    v_mfma_f32_32x32x16_bf16 v[240:255], v[44:47], v[52:55], v[240:255]
    s_cmp_lg_u32 s42, 0
    s_cbranch_scc1 L_g1_loop
    s_setprio 2
    s_and_b32 s22, s21, 3
    s_lshl_b32 s28, s20, 2
    s_add_u32 s22, s22, s28
    s_lshr_b32 s43, s21, 2
    s_mul_i32 s54, s43, 229376
    s_mul_i32 s28, s25, 28672
    s_add_u32 s54, s54, s28
    s_add_u32 s55, s54, 114688
    s_bitcmp1_b32 s25, 1
    s_cselect_b32 s28, s55, s54
    s_cselect_b32 s55, s54, s55
    s_mov_b32 s54, s28
    v_lshlrev_b32 v3, 4, v2
    v_min_u32 v4, 27, v2
    v_lshlrev_b32 v4, 2, v4
    v_add_u32 v4, 2048, v4
    v_mov_b32 v5, 0
    s_mul_i32 s34, s25, 4096
    s_mov_b32 s33, 0
    s_mov_b32 s35, s33
    v_readfirstlane_b32 s58, v26
    s_nop 3
    v_cmp_eq_u32 vcc, s58, v27
    s_nop 3
    s_cmp_eq_u64 vcc, exec
    s_cselect_b32 s29, 1, 0
    s_cmp_eq_u32 s58, 0
    s_cselect_b32 s29, 0, s29
    s_cmp_eq_u32 s29, 1
    s_cbranch_scc1 L_g_wdok
    v_mov_b32 v21, 0
    s_mov_b32 s59, 30000
L_nonce_g:
    global_load_dword v22, v21, s[46:47] sc1
    s_waitcnt vmcnt(0)
    v_readfirstlane_b32 s58, v22
    s_nop 3
    s_cmp_lg_u32 s58, 0
    s_cbranch_scc1 L_nonce_done_g
    s_sleep 1
    s_sub_u32 s59, s59, 1
    s_cmp_lg_u32 s59, 0
    s_cbranch_scc1 L_nonce_g
L_nonce_done_g:
    s_mov_b32 s59, 30000
L_poll_gwd:
    global_load_dword v22, v4, s[52:53] sc1
    s_waitcnt vmcnt(0)
    v_cmp_eq_u32 vcc, s58, v22
    s_nop 3
    s_cmp_eq_u64 vcc, exec
    s_cbranch_scc1 L_poll_done_gwd
    s_sleep 1
    s_sub_u32 s59, s59, 1
    s_cmp_lg_u32 s59, 0
    s_cbranch_scc1 L_poll_gwd
L_poll_done_gwd:
L_g_wdok:
    s_waitcnt vmcnt(4) lgkmcnt(0)
    s_barrier
    v_mfma_f32_32x32x16_bf16 v[128:143], v[56:59], v[72:75], v[128:143]
    ds_read_b128 v[48:51], v10 offset:0
    ds_read_b128 v[52:55], v10 offset:4096
    ds_read_b64_tr_b16 v[32:33], v8 offset:0
    v_mfma_f32_32x32x16_bf16 v[144:159], v[56:59], v[76:79], v[144:159]
    ds_read_b64_tr_b16 v[34:35], v8 offset:1024
    ds_read_b64_tr_b16 v[36:37], v9 offset:0
    ds_read_b64_tr_b16 v[38:39], v9 offset:1024
    v_mfma_f32_32x32x16_bf16 v[160:175], v[60:63], v[72:75], v[160:175]
    ds_read_b64_tr_b16 v[40:41], v8 offset:8192
    ds_read_b64_tr_b16 v[42:43], v8 offset:9216
    v_mfma_f32_32x32x16_bf16 v[176:191], v[60:63], v[76:79], v[176:191]
    ds_read_b64_tr_b16 v[44:45], v9 offset:8192
    ds_read_b64_tr_b16 v[46:47], v9 offset:9216
    v_mfma_f32_32x32x16_bf16 v[192:207], v[64:67], v[72:75], v[192:207]
    s_add_u32 s28, s54, s35
    buffer_load_dwordx4 v[80:83], v3, s[48:51], s28 offen offset:0 sc1
    v_mfma_f32_32x32x16_bf16 v[208:223], v[64:67], v[76:79], v[208:223]
    s_add_u32 s28, s55, s35
    buffer_load_dwordx4 v[84:87], v3, s[48:51], s28 offen offset:0 sc1
    v_mfma_f32_32x32x16_bf16 v[224:239], v[68:71], v[72:75], v[224:239]
    s_add_u32 s28, s54, s35
    buffer_load_dwordx4 v[88:91], v3, s[48:51], s28 offen offset:1024 sc1
    v_mfma_f32_32x32x16_bf16 v[240:255], v[68:71], v[76:79], v[240:255]
    s_add_u32 s28, s55, s35
    buffer_load_dwordx4 v[92:95], v3, s[48:51], s28 offen offset:1024 sc1
    s_waitcnt lgkmcnt(0)
    v_mfma_f32_32x32x16_bf16 v[128:143], v[32:35], v[48:51], v[128:143]
    ds_read_b128 v[72:75], v11 offset:0
    ds_read_b128 v[76:79], v11 offset:4096
    ds_read_b64_tr_b16 v[56:57], v8 offset:4096
    v_mfma_f32_32x32x16_bf16 v[144:159], v[32:35], v[52:55], v[144:159]
    ds_read_b64_tr_b16 v[58:59], v8 offset:5120
    ds_read_b64_tr_b16 v[60:61], v9 offset:4096
    ds_read_b64_tr_b16 v[62:63], v9 offset:5120
    v_mfma_f32_32x32x16_bf16 v[160:175], v[36:39], v[48:51], v[160:175]
    ds_read_b64_tr_b16 v[64:65], v8 offset:12288
    ds_read_b64_tr_b16 v[66:67], v8 offset:13312
    v_mfma_f32_32x32x16_bf16 v[176:191], v[36:39], v[52:55], v[176:191]
    ds_read_b64_tr_b16 v[68:69], v9 offset:12288
    ds_read_b64_tr_b16 v[70:71], v9 offset:13312
    v_mfma_f32_32x32x16_bf16 v[192:207], v[40:43], v[48:51], v[192:207]
    s_add_u32 s28, s54, s35
    buffer_load_dwordx4 v[96:99], v3, s[48:51], s28 offen offset:2048 sc1
    s_mov_b32 s36, s41
    s_add_u32 s41, s41, 16384
    v_mfma_f32_32x32x16_bf16 v[208:223], v[40:43], v[52:55], v[208:223]
    s_add_u32 s28, s55, s35
    buffer_load_dwordx4 v[100:103], v3, s[48:51], s28 offen offset:2048 sc1
    s_cmp_eq_u32 s41, 49152
    s_cselect_b32 s41, 0, s41
    v_mfma_f32_32x32x16_bf16 v[224:239], v[44:47], v[48:51], v[224:239]
    s_add_u32 s28, s54, s35
    buffer_load_dwordx4 v[104:107], v3, s[48:51], s28 offen offset:3072 sc1
    v_add_u32 v8, s41, v6
    v_add_u32 v9, s41, v7
    v_mfma_f32_32x32x16_bf16 v[240:255], v[44:47], v[52:55], v[240:255]
    s_add_u32 s28, s55, s35
    buffer_load_dwordx4 v[108:111], v3, s[48:51], s28 offen offset:3072 sc1
    s_add_u32 s35, s35, 4096
    s_cmp_eq_u32 s35, 28672
    s_cselect_b32 s35, 0, s35
    s_waitcnt vmcnt(8) lgkmcnt(0)
    s_barrier
    v_mfma_f32_32x32x16_bf16 v[128:143], v[56:59], v[72:75], v[128:143]
    ds_read_b128 v[48:51], v12 offset:0
    ds_read_b128 v[52:55], v12 offset:4096
    ds_read_b64_tr_b16 v[32:33], v8 offset:0
    v_mfma_f32_32x32x16_bf16 v[144:159], v[56:59], v[76:79], v[144:159]
    ds_read_b64_tr_b16 v[34:35], v8 offset:1024
    ds_read_b64_tr_b16 v[36:37], v9 offset:0
    ds_read_b64_tr_b16 v[38:39], v9 offset:1024
    v_mfma_f32_32x32x16_bf16 v[160:175], v[60:63], v[72:75], v[160:175]
    ds_read_b64_tr_b16 v[40:41], v8 offset:8192
    ds_read_b64_tr_b16 v[42:43], v8 offset:9216
    v_mfma_f32_32x32x16_bf16 v[176:191], v[60:63], v[76:79], v[176:191]
    ds_read_b64_tr_b16 v[44:45], v9 offset:8192
    ds_read_b64_tr_b16 v[46:47], v9 offset:9216
    v_mfma_f32_32x32x16_bf16 v[192:207], v[64:67], v[72:75], v[192:207]
    s_add_u32 s28, s54, s35
    buffer_load_dwordx4 v[112:115], v3, s[48:51], s28 offen offset:0 sc1
    v_mfma_f32_32x32x16_bf16 v[208:223], v[64:67], v[76:79], v[208:223]
    s_add_u32 s28, s55, s35
    buffer_load_dwordx4 v[116:119], v3, s[48:51], s28 offen offset:0 sc1
    v_mfma_f32_32x32x16_bf16 v[224:239], v[68:71], v[72:75], v[224:239]
    s_add_u32 s28, s54, s35
    buffer_load_dwordx4 v[120:123], v3, s[48:51], s28 offen offset:1024 sc1
    v_mfma_f32_32x32x16_bf16 v[240:255], v[68:71], v[76:79], v[240:255]
    s_add_u32 s28, s55, s35
    buffer_load_dwordx4 v[124:127], v3, s[48:51], s28 offen offset:1024 sc1
    s_waitcnt lgkmcnt(0)
    v_mfma_f32_32x32x16_bf16 v[128:143], v[32:35], v[48:51], v[128:143]
    ds_read_b128 v[72:75], v13 offset:0
    ds_read_b128 v[76:79], v13 offset:4096
    ds_read_b64_tr_b16 v[56:57], v8 offset:4096
    v_mfma_f32_32x32x16_bf16 v[144:159], v[32:35], v[52:55], v[144:159]
    ds_read_b64_tr_b16 v[58:59], v8 offset:5120
    ds_read_b64_tr_b16 v[60:61], v9 offset:4096
    ds_read_b64_tr_b16 v[62:63], v9 offset:5120
    v_mfma_f32_32x32x16_bf16 v[160:175], v[36:39], v[48:51], v[160:175]
    ds_read_b64_tr_b16 v[64:65], v8 offset:12288
    ds_read_b64_tr_b16 v[66:67], v8 offset:13312
    v_mfma_f32_32x32x16_bf16 v[176:191], v[36:39], v[52:55], v[176:191]
    ds_read_b64_tr_b16 v[68:69], v9 offset:12288
    ds_read_b64_tr_b16 v[70:71], v9 offset:13312
    v_mfma_f32_32x32x16_bf16 v[192:207], v[40:43], v[48:51], v[192:207]
    s_add_u32 m0, s34, 16384
    s_add_u32 s28, s54, s35
    s_add_u32 s28, s28, 2048
    buffer_load_dwordx4 v3, s[48:51], s28 offen sc1 lds
    s_mov_b32 s36, s41
    s_add_u32 s41, s41, 16384
    s_cmp_eq_u32 s41, 49152
    v_mfma_f32_32x32x16_bf16 v[208:223], v[40:43], v[52:55], v[208:223]
    s_add_u32 m0, s34, 17408
    s_add_u32 s28, s55, s35
    s_add_u32 s28, s28, 2048
    buffer_load_dwordx4 v3, s[48:51], s28 offen sc1 lds
    s_cselect_b32 s41, 0, s41
    v_add_u32 v8, s41, v6
    v_add_u32 v9, s41, v7
    v_mfma_f32_32x32x16_bf16 v[224:239], v[44:47], v[48:51], v[224:239]
    s_add_u32 m0, s34, 18432
    s_add_u32 s28, s54, s35
    s_add_u32 s28, s28, 3072
    buffer_load_dwordx4 v3, s[48:51], s28 offen sc1 lds
    v_xor_b32 v10, 16384, v10
    v_xor_b32 v11, 16384, v11
    v_xor_b32 v12, 16384, v12
    v_mfma_f32_32x32x16_bf16 v[240:255], v[44:47], v[52:55], v[240:255]
    s_add_u32 m0, s34, 19456
    s_add_u32 s28, s55, s35
    s_add_u32 s28, s28, 3072
    buffer_load_dwordx4 v3, s[48:51], s28 offen sc1 lds
    s_add_u32 s35, s35, 4096
    s_cmp_eq_u32 s35, 28672
    s_cselect_b32 s35, 0, s35
    v_xor_b32 v13, 16384, v13
    s_xor_b32 s37, s37, 16384
    s_waitcnt lgkmcnt(0)
    s_barrier
    v_mfma_f32_32x32x16_bf16 v[128:143], v[56:59], v[72:75], v[128:143]
    s_add_u32 m0, s34, 65536
    s_add_u32 s28, s54, s35
    buffer_load_dwordx4 v3, s[48:51], s28 offen sc1 lds
    v_mfma_f32_32x32x16_bf16 v[192:207], v[64:67], v[72:75], v[192:207]
    s_add_u32 m0, s34, 66560
    s_add_u32 s28, s55, s35
    buffer_load_dwordx4 v3, s[48:51], s28 offen sc1 lds
    v_mfma_f32_32x32x16_bf16 v[144:159], v[56:59], v[76:79], v[144:159]
    s_add_u32 m0, s34, 67584
    s_add_u32 s28, s54, s35
    s_add_u32 s28, s28, 1024
    buffer_load_dwordx4 v3, s[48:51], s28 offen sc1 lds
    v_mfma_f32_32x32x16_bf16 v[208:223], v[64:67], v[76:79], v[208:223]
    s_add_u32 m0, s34, 68608
    s_add_u32 s28, s55, s35
    s_add_u32 s28, s28, 1024
    buffer_load_dwordx4 v3, s[48:51], s28 offen sc1 lds
    v_mfma_f32_32x32x16_bf16 v[160:175], v[60:63], v[72:75], v[160:175]
    s_add_u32 m0, s34, 32768
    s_add_u32 s28, s54, s35
    s_add_u32 s28, s28, 2048
    buffer_load_dwordx4 v3, s[48:51], s28 offen sc1 lds
    v_mfma_f32_32x32x16_bf16 v[224:239], v[68:71], v[72:75], v[224:239]
    s_add_u32 m0, s34, 33792
    s_add_u32 s28, s55, s35
    s_add_u32 s28, s28, 2048
    buffer_load_dwordx4 v3, s[48:51], s28 offen sc1 lds
    v_mfma_f32_32x32x16_bf16 v[176:191], v[60:63], v[76:79], v[176:191]
    s_add_u32 m0, s34, 34816
    s_add_u32 s28, s54, s35
    s_add_u32 s28, s28, 3072
    buffer_load_dwordx4 v3, s[48:51], s28 offen sc1 lds
    v_mfma_f32_32x32x16_bf16 v[240:255], v[68:71], v[76:79], v[240:255]
    s_add_u32 m0, s34, 35840
    s_add_u32 s28, s55, s35
    s_add_u32 s28, s28, 3072
    buffer_load_dwordx4 v3, s[48:51], s28 offen sc1 lds
    s_add_u32 s35, s35, 4096
    s_cmp_eq_u32 s35, 28672
    s_cselect_b32 s35, 0, s35
    s_setprio 2
    s_lshl_b32 s29, s23, 2
    s_lshl_b32 s30, s27, 1
    s_add_u32 s29, s29, s30
    s_mul_i32 s29, s29, 112
    s_lshl_b32 s30, s24, 3
    s_add_u32 s29, s29, s30
    s_lshl_b32 s30, s26, 2
    s_add_u32 s30, s29, s30
    s_lshl_b32 s30, s30, 10
    v_cvt_pk_bf16_f32 v128, 0, v128
    v_cvt_pk_bf16_f32 v192, 0, v192
    v_cvt_pk_bf16_f32 v129, 0, v129
    v_cvt_pk_bf16_f32 v193, 0, v193
    v_cvt_pk_bf16_f32 v130, 0, v130
    v_cvt_pk_bf16_f32 v194, 0, v194
    v_cvt_pk_bf16_f32 v131, 0, v131
    v_cvt_pk_bf16_f32 v195, 0, v195
    v_cvt_pk_bf16_f32 v132, 0, v132
    v_cvt_pk_bf16_f32 v196, 0, v196
    v_cvt_pk_bf16_f32 v133, 0, v133
    v_cvt_pk_bf16_f32 v197, 0, v197
    v_cvt_pk_bf16_f32 v134, 0, v134
    v_cvt_pk_bf16_f32 v198, 0, v198
    v_cvt_pk_bf16_f32 v135, 0, v135
    v_cvt_pk_bf16_f32 v199, 0, v199
    v_cvt_pk_bf16_f32 v136, 0, v136
    v_cvt_pk_bf16_f32 v200, 0, v200
    v_cvt_pk_bf16_f32 v137, 0, v137
    v_cvt_pk_bf16_f32 v201, 0, v201
    v_cvt_pk_bf16_f32 v138, 0, v138
    v_cvt_pk_bf16_f32 v202, 0, v202
    v_cvt_pk_bf16_f32 v139, 0, v139
    v_cvt_pk_bf16_f32 v203, 0, v203
    v_cvt_pk_bf16_f32 v140, 0, v140
    v_cvt_pk_bf16_f32 v204, 0, v204
    v_cvt_pk_bf16_f32 v141, 0, v141
    v_cvt_pk_bf16_f32 v205, 0, v205
    v_cvt_pk_bf16_f32 v142, 0, v142
    v_cvt_pk_bf16_f32 v206, 0, v206
    v_cvt_pk_bf16_f32 v143, 0, v143
    v_cvt_pk_bf16_f32 v207, 0, v207
    v_pk_mul_f32 v[128:129], v[128:129], v[192:193]
    v_pk_mul_f32 v[130:131], v[130:131], v[194:195]
    v_pk_mul_f32 v[132:133], v[132:133], v[196:197]
    v_pk_mul_f32 v[134:135], v[134:135], v[198:199]
    v_pk_mul_f32 v[136:137], v[136:137], v[200:201]
    v_pk_mul_f32 v[138:139], v[138:139], v[202:203]
    v_pk_mul_f32 v[140:141], v[140:141], v[204:205]
    v_pk_mul_f32 v[142:143], v[142:143], v[206:207]
    v_cvt_pk_bf16_f32 v128, v128, v129
    v_cvt_pk_bf16_f32 v129, v130, v131
    v_cvt_pk_bf16_f32 v130, v132, v133
    v_cvt_pk_bf16_f32 v131, v134, v135
    v_cvt_pk_bf16_f32 v132, v136, v137
    v_cvt_pk_bf16_f32 v133, v138, v139
    v_cvt_pk_bf16_f32 v134, v140, v141
    v_cvt_pk_bf16_f32 v135, v142, v143
    s_add_u32 s29, s30, 0
    buffer_store_dwordx4 v[128:131], v3, s[16:19], s29 offen sc1
    buffer_store_dwordx4 v[132:135], v3, s[16:19], s29 offen offset:1024 sc1
    v_cvt_pk_bf16_f32 v144, 0, v144
    v_cvt_pk_bf16_f32 v208, 0, v208
    v_cvt_pk_bf16_f32 v145, 0, v145
    v_cvt_pk_bf16_f32 v209, 0, v209
    v_cvt_pk_bf16_f32 v146, 0, v146
    v_cvt_pk_bf16_f32 v210, 0, v210
    v_cvt_pk_bf16_f32 v147, 0, v147
    v_cvt_pk_bf16_f32 v211, 0, v211
    v_cvt_pk_bf16_f32 v148, 0, v148
    v_cvt_pk_bf16_f32 v212, 0, v212
    v_cvt_pk_bf16_f32 v149, 0, v149
    v_cvt_pk_bf16_f32 v213, 0, v213
    v_cvt_pk_bf16_f32 v150, 0, v150
    v_cvt_pk_bf16_f32 v214, 0, v214
    v_cvt_pk_bf16_f32 v151, 0, v151
    v_cvt_pk_bf16_f32 v215, 0, v215
    v_cvt_pk_bf16_f32 v152, 0, v152
    v_cvt_pk_bf16_f32 v216, 0, v216
    v_cvt_pk_bf16_f32 v153, 0, v153
    v_cvt_pk_bf16_f32 v217, 0, v217
    v_cvt_pk_bf16_f32 v154, 0, v154
    v_cvt_pk_bf16_f32 v218, 0, v218
    v_cvt_pk_bf16_f32 v155, 0, v155
    v_cvt_pk_bf16_f32 v219, 0, v219
    v_cvt_pk_bf16_f32 v156, 0, v156
    v_cvt_pk_bf16_f32 v220, 0, v220
    v_cvt_pk_bf16_f32 v157, 0, v157
    v_cvt_pk_bf16_f32 v221, 0, v221
    v_cvt_pk_bf16_f32 v158, 0, v158
    v_cvt_pk_bf16_f32 v222, 0, v222
    v_cvt_pk_bf16_f32 v159, 0, v159
    v_cvt_pk_bf16_f32 v223, 0, v223
    v_pk_mul_f32 v[144:145], v[144:145], v[208:209]
    v_pk_mul_f32 v[146:147], v[146:147], v[210:211]
    v_pk_mul_f32 v[148:149], v[148:149], v[212:213]
    v_pk_mul_f32 v[150:151], v[150:151], v[214:215]
    v_pk_mul_f32 v[152:153], v[152:153], v[216:217]
    v_pk_mul_f32 v[154:155], v[154:155], v[218:219]
    v_pk_mul_f32 v[156:157], v[156:157], v[220:221]
    v_pk_mul_f32 v[158:159], v[158:159], v[222:223]
    v_cvt_pk_bf16_f32 v144, v144, v145
    v_cvt_pk_bf16_f32 v145, v146, v147
    v_cvt_pk_bf16_f32 v146, v148, v149
    v_cvt_pk_bf16_f32 v147, v150, v151
    v_cvt_pk_bf16_f32 v148, v152, v153
    v_cvt_pk_bf16_f32 v149, v154, v155
    v_cvt_pk_bf16_f32 v150, v156, v157
    v_cvt_pk_bf16_f32 v151, v158, v159
    s_add_u32 s29, s30, 114688
    buffer_store_dwordx4 v[144:147], v3, s[16:19], s29 offen sc1
    buffer_store_dwordx4 v[148:151], v3, s[16:19], s29 offen offset:1024 sc1
    v_cvt_pk_bf16_f32 v160, 0, v160
    v_cvt_pk_bf16_f32 v224, 0, v224
    v_cvt_pk_bf16_f32 v161, 0, v161
    v_cvt_pk_bf16_f32 v225, 0, v225
    v_cvt_pk_bf16_f32 v162, 0, v162
    v_cvt_pk_bf16_f32 v226, 0, v226
    v_cvt_pk_bf16_f32 v163, 0, v163
    v_cvt_pk_bf16_f32 v227, 0, v227
    v_cvt_pk_bf16_f32 v164, 0, v164
    v_cvt_pk_bf16_f32 v228, 0, v228
    v_cvt_pk_bf16_f32 v165, 0, v165
    v_cvt_pk_bf16_f32 v229, 0, v229
    v_cvt_pk_bf16_f32 v166, 0, v166
    v_cvt_pk_bf16_f32 v230, 0, v230
    v_cvt_pk_bf16_f32 v167, 0, v167
    v_cvt_pk_bf16_f32 v231, 0, v231
    v_cvt_pk_bf16_f32 v168, 0, v168
    v_cvt_pk_bf16_f32 v232, 0, v232
    v_cvt_pk_bf16_f32 v169, 0, v169
    v_cvt_pk_bf16_f32 v233, 0, v233
    v_cvt_pk_bf16_f32 v170, 0, v170
    v_cvt_pk_bf16_f32 v234, 0, v234
    v_cvt_pk_bf16_f32 v171, 0, v171
    v_cvt_pk_bf16_f32 v235, 0, v235
    v_cvt_pk_bf16_f32 v172, 0, v172
    v_cvt_pk_bf16_f32 v236, 0, v236
    v_cvt_pk_bf16_f32 v173, 0, v173
    v_cvt_pk_bf16_f32 v237, 0, v237
    v_cvt_pk_bf16_f32 v174, 0, v174
    v_cvt_pk_bf16_f32 v238, 0, v238
    v_cvt_pk_bf16_f32 v175, 0, v175
    v_cvt_pk_bf16_f32 v239, 0, v239
    v_pk_mul_f32 v[160:161], v[160:161], v[224:225]
    v_pk_mul_f32 v[162:163], v[162:163], v[226:227]
    v_pk_mul_f32 v[164:165], v[164:165], v[228:229]
    v_pk_mul_f32 v[166:167], v[166:167], v[230:231]
    v_pk_mul_f32 v[168:169], v[168:169], v[232:233]
    v_pk_mul_f32 v[170:171], v[170:171], v[234:235]
    v_pk_mul_f32 v[172:173], v[172:173], v[236:237]
    v_pk_mul_f32 v[174:175], v[174:175], v[238:239]
    v_cvt_pk_bf16_f32 v160, v160, v161
    v_cvt_pk_bf16_f32 v161, v162, v163
    v_cvt_pk_bf16_f32 v162, v164, v165
    v_cvt_pk_bf16_f32 v163, v166, v167
    v_cvt_pk_bf16_f32 v164, v168, v169
    v_cvt_pk_bf16_f32 v165, v170, v171
    v_cvt_pk_bf16_f32 v166, v172, v173
    v_cvt_pk_bf16_f32 v167, v174, v175
    s_add_u32 s29, s30, 2048
    buffer_store_dwordx4 v[160:163], v3, s[16:19], s29 offen sc1
    buffer_store_dwordx4 v[164:167], v3, s[16:19], s29 offen offset:1024 sc1
    v_cvt_pk_bf16_f32 v176, 0, v176
    v_cvt_pk_bf16_f32 v240, 0, v240
    v_cvt_pk_bf16_f32 v177, 0, v177
    v_cvt_pk_bf16_f32 v241, 0, v241
    v_cvt_pk_bf16_f32 v178, 0, v178
    v_cvt_pk_bf16_f32 v242, 0, v242
    v_cvt_pk_bf16_f32 v179, 0, v179
    v_cvt_pk_bf16_f32 v243, 0, v243
    v_cvt_pk_bf16_f32 v180, 0, v180
    v_cvt_pk_bf16_f32 v244, 0, v244
    v_cvt_pk_bf16_f32 v181, 0, v181
    v_cvt_pk_bf16_f32 v245, 0, v245
    v_cvt_pk_bf16_f32 v182, 0, v182
    v_cvt_pk_bf16_f32 v246, 0, v246
    v_cvt_pk_bf16_f32 v183, 0, v183
    v_cvt_pk_bf16_f32 v247, 0, v247
    v_cvt_pk_bf16_f32 v184, 0, v184
    v_cvt_pk_bf16_f32 v248, 0, v248
    v_cvt_pk_bf16_f32 v185, 0, v185
    v_cvt_pk_bf16_f32 v249, 0, v249
    v_cvt_pk_bf16_f32 v186, 0, v186
    v_cvt_pk_bf16_f32 v250, 0, v250
    v_cvt_pk_bf16_f32 v187, 0, v187
    v_cvt_pk_bf16_f32 v251, 0, v251
    v_cvt_pk_bf16_f32 v188, 0, v188
    v_cvt_pk_bf16_f32 v252, 0, v252
    v_cvt_pk_bf16_f32 v189, 0, v189
    v_cvt_pk_bf16_f32 v253, 0, v253
    v_cvt_pk_bf16_f32 v190, 0, v190
    v_cvt_pk_bf16_f32 v254, 0, v254
    v_cvt_pk_bf16_f32 v191, 0, v191
    v_cvt_pk_bf16_f32 v255, 0, v255
    v_pk_mul_f32 v[176:177], v[176:177], v[240:241]
    v_pk_mul_f32 v[178:179], v[178:179], v[242:243]
    v_pk_mul_f32 v[180:181], v[180:181], v[244:245]
    v_pk_mul_f32 v[182:183], v[182:183], v[246:247]
    v_pk_mul_f32 v[184:185], v[184:185], v[248:249]
    v_pk_mul_f32 v[186:187], v[186:187], v[250:251]
    v_pk_mul_f32 v[188:189], v[188:189], v[252:253]
    v_pk_mul_f32 v[190:191], v[190:191], v[254:255]
    v_cvt_pk_bf16_f32 v176, v176, v177
    v_cvt_pk_bf16_f32 v177, v178, v179
    v_cvt_pk_bf16_f32 v178, v180, v181
    v_cvt_pk_bf16_f32 v179, v182, v183
    v_cvt_pk_bf16_f32 v180, v184, v185
    v_cvt_pk_bf16_f32 v181, v186, v187
    v_cvt_pk_bf16_f32 v182, v188, v189
    v_cvt_pk_bf16_f32 v183, v190, v191
    s_add_u32 s29, s30, 116736
    buffer_store_dwordx4 v[176:179], v3, s[16:19], s29 offen sc1
    buffer_store_dwordx4 v[180:183], v3, s[16:19], s29 offen offset:1024 sc1
    s_add_u32 m0, s34, 0
    s_add_u32 s28, s54, s35
    buffer_load_dwordx4 v3, s[48:51], s28 offen sc1 lds
    s_add_u32 m0, s34, 1024
    s_add_u32 s28, s55, s35
    buffer_load_dwordx4 v3, s[48:51], s28 offen sc1 lds
    s_waitcnt vmcnt(2)
    s_lshl_b32 s28, s23, 7
    s_lshl_b32 s29, s24, 2
    s_add_u32 s28, s28, s29
    s_add_u32 s28, s28, 0
    s_barrier
    v_mov_b32 v14, s28
    v_mov_b32 v15, s58
    v_cmp_eq_u32 vcc, 0, v0
    s_nop 3
    s_and_saveexec_b64 s[56:57], vcc
    s_cbranch_execz L_pub_h
    global_store_dword v14, v15, s[52:53] sc0 sc1
L_pub_h:
    s_mov_b64 exec, s[56:57]
    s_setprio 0
    s_add_u32 m0, s34, 2048
    s_add_u32 s28, s54, s35
    s_add_u32 s28, s28, 1024
    buffer_load_dwordx4 v3, s[48:51], s28 offen sc1 lds
    s_add_u32 m0, s34, 3072
    s_add_u32 s28, s55, s35
    s_add_u32 s28, s28, 1024
    buffer_load_dwordx4 v3, s[48:51], s28 offen sc1 lds
    s_add_u32 m0, s34, 49152
    s_add_u32 s28, s54, s35
    s_add_u32 s28, s28, 2048
    buffer_load_dwordx4 v3, s[48:51], s28 offen sc1 lds
    s_add_u32 m0, s34, 50176
    s_add_u32 s28, s55, s35
    s_add_u32 s28, s28, 2048
    buffer_load_dwordx4 v3, s[48:51], s28 offen sc1 lds
    s_add_u32 m0, s34, 51200
    s_add_u32 s28, s54, s35
    s_add_u32 s28, s28, 3072
    buffer_load_dwordx4 v3, s[48:51], s28 offen sc1 lds
    s_add_u32 m0, s34, 52224
    s_add_u32 s28, s55, s35
    s_add_u32 s28, s28, 3072
    buffer_load_dwordx4 v3, s[48:51], s28 offen sc1 lds
    s_add_u32 s35, s35, 4096
    s_cmp_eq_u32 s35, 28672
    s_cselect_b32 s35, 0, s35
    s_add_u32 s28, s54, s35
    buffer_load_dwordx4 v[32:35], v3, s[48:51], s28 offen offset:0 sc1
    s_add_u32 s28, s55, s35
    buffer_load_dwordx4 v[36:39], v3, s[48:51], s28 offen offset:0 sc1
    s_add_u32 s28, s54, s35
    buffer_load_dwordx4 v[40:43], v3, s[48:51], s28 offen offset:1024 sc1
    s_add_u32 s28, s55, s35
    buffer_load_dwordx4 v[44:47], v3, s[48:51], s28 offen offset:1024 sc1
    s_add_u32 s28, s54, s35
    buffer_load_dwordx4 v[48:51], v3, s[48:51], s28 offen offset:2048 sc1
    s_add_u32 s28, s55, s35
    buffer_load_dwordx4 v[52:55], v3, s[48:51], s28 offen offset:2048 sc1
    s_add_u32 s28, s54, s35
    buffer_load_dwordx4 v[56:59], v3, s[48:51], s28 offen offset:3072 sc1
    s_add_u32 s28, s55, s35
    buffer_load_dwordx4 v[60:63], v3, s[48:51], s28 offen offset:3072 sc1
    s_add_u32 s35, s35, 4096
    s_cmp_eq_u32 s35, 28672
    s_cselect_b32 s35, 0, s35
    s_add_u32 s28, s54, s35
    buffer_load_dwordx4 v[64:67], v3, s[48:51], s28 offen offset:0 sc1
    s_add_u32 s28, s55, s35
    buffer_load_dwordx4 v[68:71], v3, s[48:51], s28 offen offset:0 sc1
    s_add_u32 s28, s54, s35
    buffer_load_dwordx4 v[72:75], v3, s[48:51], s28 offen offset:1024 sc1
    s_add_u32 s28, s55, s35
    buffer_load_dwordx4 v[76:79], v3, s[48:51], s28 offen offset:1024 sc1
    s_add_u32 s28, s54, s35
    buffer_load_dwordx4 v[192:195], v3, s[48:51], s28 offen offset:2048 sc1
    s_add_u32 s28, s55, s35
    buffer_load_dwordx4 v[196:199], v3, s[48:51], s28 offen offset:2048 sc1
    s_add_u32 s28, s54, s35
    buffer_load_dwordx4 v[200:203], v3, s[48:51], s28 offen offset:3072 sc1
    s_add_u32 s28, s55, s35
    buffer_load_dwordx4 v[204:207], v3, s[48:51], s28 offen offset:3072 sc1
    s_add_u32 s35, s35, 4096
    s_cmp_eq_u32 s35, 28672
    s_cselect_b32 s35, 0, s35
    s_add_u32 s28, s54, s35
    buffer_load_dwordx4 v[208:211], v3, s[48:51], s28 offen offset:0 sc1
    s_add_u32 s28, s55, s35
    buffer_load_dwordx4 v[212:215], v3, s[48:51], s28 offen offset:0 sc1
    s_add_u32 s28, s54, s35
    buffer_load_dwordx4 v[216:219], v3, s[48:51], s28 offen offset:1024 sc1
    s_add_u32 s28, s55, s35
    buffer_load_dwordx4 v[220:223], v3, s[48:51], s28 offen offset:1024 sc1
    s_add_u32 s28, s54, s35
    buffer_load_dwordx4 v[224:227], v3, s[48:51], s28 offen offset:2048 sc1
    s_add_u32 s28, s55, s35
    buffer_load_dwordx4 v[228:231], v3, s[48:51], s28 offen offset:2048 sc1
    s_add_u32 s28, s54, s35
    buffer_load_dwordx4 v[232:235], v3, s[48:51], s28 offen offset:3072 sc1
    s_add_u32 s28, s55, s35
    buffer_load_dwordx4 v[236:239], v3, s[48:51], s28 offen offset:3072 sc1
    s_add_u32 s35, s35, 4096
    s_cmp_eq_u32 s35, 28672
    s_cselect_b32 s35, 0, s35
    v_mov_b32 v128, 0
    v_mov_b32 v129, 0
    v_mov_b32 v130, 0
    v_mov_b32 v131, 0
    v_mov_b32 v132, 0
    v_mov_b32 v133, 0
    v_mov_b32 v134, 0
    v_mov_b32 v135, 0
    v_mov_b32 v136, 0
    v_mov_b32 v137, 0
    v_mov_b32 v138, 0
    v_mov_b32 v139, 0
    v_mov_b32 v140, 0
    v_mov_b32 v141, 0
    v_mov_b32 v142, 0
    v_mov_b32 v143, 0
    v_mov_b32 v144, 0
    v_mov_b32 v145, 0
    v_mov_b32 v146, 0
    v_mov_b32 v147, 0
    v_mov_b32 v148, 0
    v_mov_b32 v149, 0
    v_mov_b32 v150, 0
    v_mov_b32 v151, 0
    v_mov_b32 v152, 0
    v_mov_b32 v153, 0
    v_mov_b32 v154, 0
    v_mov_b32 v155, 0
    v_mov_b32 v156, 0
    v_mov_b32 v157, 0
    v_mov_b32 v158, 0
    v_mov_b32 v159, 0
    v_mov_b32 v160, 0
    v_mov_b32 v161, 0
    v_mov_b32 v162, 0
    v_mov_b32 v163, 0
    v_mov_b32 v164, 0
    v_mov_b32 v165, 0
    v_mov_b32 v166, 0
    v_mov_b32 v167, 0
    v_mov_b32 v168, 0
    v_mov_b32 v169, 0
    v_mov_b32 v170, 0
    v_mov_b32 v171, 0
    v_mov_b32 v172, 0
    v_mov_b32 v173, 0
    v_mov_b32 v174, 0
    v_mov_b32 v175, 0
    v_mov_b32 v176, 0
    v_mov_b32 v177, 0
    v_mov_b32 v178, 0
    v_mov_b32 v179, 0
    v_mov_b32 v180, 0
    v_mov_b32 v181, 0
    v_mov_b32 v182, 0
    v_mov_b32 v183, 0
    v_mov_b32 v184, 0
    v_mov_b32 v185, 0
    v_mov_b32 v186, 0
    v_mov_b32 v187, 0
    v_mov_b32 v188, 0
    v_mov_b32 v189, 0
    v_mov_b32 v190, 0
    v_mov_b32 v191, 0
    s_mul_i32 s30, s22, 229376
    s_mul_i32 s28, s25, 28672
    s_add_u32 s30, s30, s28
    s_add_u32 s31, s30, 114688
    s_bitcmp1_b32 s25, 0
    s_cselect_b32 s28, s31, s30
    s_cselect_b32 s31, s30, s31
    s_mov_b32 s30, s28
    s_lshr_b32 s28, s22, 1
    s_lshl_b32 s28, s28, 7
    v_min_u32 v4, 13, v2
    v_lshlrev_b32 v4, 2, v4
    v_add_u32 v4, s28, v4
    v_add_u32 v9, s34, v3
    v_add_u32 v12, 65536, v9
    s_lshr_b32 s36, s25, 1
    s_and_b32 s37, s25, 1
    s_add_u32 s38, s16, 10027008
    s_addc_u32 s39, s17, 0
    s_lshl_b32 s40, s22, 6
    s_lshl_b32 s41, s37, 5
    s_add_u32 s40, s40, s41
    v_and_b32 v10, 31, v2
    v_add_u32 v5, s40, v10
    v_lshlrev_b32 v6, 2, v5
    s_lshl_b32 s28, s43, 7
    v_lshlrev_b32 v8, 2, v10
    v_add_u32 v8, s28, v8
    v_add_u32 v8, 3328, v8
    s_lshl_b32 s28, s22, 2
    s_add_u32 s28, s28, 2176
    v_mov_b32 v7, s28
    v_cmp_gt_u32 vcc, 32, v2
    s_nop 1
    v_cndmask_b32 v8, v7, v8, vcc
    s_add_u32 s4, s16, 12582912
    s_addc_u32 s5, s17, 0
    s_mov_b32 s6, 1835008
    s_mov_b32 s7, 0x20000
    v_lshrrev_b32 v7, 3, v2
    v_lshlrev_b32 v7, 12, v7
    v_and_b32 v10, 7, v2
    v_lshl_add_u32 v7, v10, 4, v7
    s_lshl_b32 s28, s43, 6
    s_lshl_b32 s29, s25, 4
    s_add_u32 s28, s28, s29
    s_lshl_b32 s28, s28, 12
    s_lshl_b32 s29, s22, 7
    s_add_u32 s35, s28, s29
    s_add_u32 s34, s35, 32768
    s_waitcnt vmcnt(0)
    s_cmp_lg_u32 s25, 0
    s_cbranch_scc1 L_pw_done_gh
    s_mov_b32 s59, 30000
L_pw_gh:
    global_load_dword v15, v4, s[52:53] sc1
    s_waitcnt vmcnt(0)
    v_cmp_eq_u32 vcc, s58, v15
    s_nop 3
    s_cmp_eq_u64 vcc, exec
    s_cbranch_scc1 L_pw_done_gh
    s_sleep 1
    s_sub_u32 s59, s59, 1
    s_cmp_lg_u32 s59, 0
    s_cbranch_scc1 L_pw_gh
L_pw_done_gh:
    s_barrier
    s_add_u32 s32, s30, s33
    s_add_u32 s42, s31, s33
    s_add_u32 s33, s33, 4096
    s_cmp_eq_u32 s33, 28672
    s_cselect_b32 s33, 0, s33
    buffer_load_dwordx4 v[16:19], v3, s[16:19], s32 offen offset:0 sc1
    buffer_load_dwordx4 v[20:23], v3, s[16:19], s42 offen offset:0 sc1
    buffer_load_dwordx4 v[24:27], v3, s[16:19], s32 offen offset:1024 sc1
    buffer_load_dwordx4 v[28:31], v3, s[16:19], s42 offen offset:1024 sc1
    buffer_load_dwordx4 v[240:243], v3, s[16:19], s32 offen offset:2048 sc1
    buffer_load_dwordx4 v[244:247], v3, s[16:19], s42 offen offset:2048 sc1
    buffer_load_dwordx4 v[248:251], v3, s[16:19], s32 offen offset:3072 sc1
    buffer_load_dwordx4 v[252:255], v3, s[16:19], s42 offen offset:3072 sc1
    s_waitcnt vmcnt(6)
    v_mfma_f32_32x32x16_bf16 v[128:143], v[80:83], v[16:19], v[128:143]
    v_mfma_f32_32x32x16_bf16 v[144:159], v[80:83], v[20:23], v[144:159]
    v_mfma_f32_32x32x16_bf16 v[160:175], v[84:87], v[16:19], v[160:175]
    v_mfma_f32_32x32x16_bf16 v[176:191], v[84:87], v[20:23], v[176:191]
    s_waitcnt vmcnt(4)
    v_mfma_f32_32x32x16_bf16 v[128:143], v[88:91], v[24:27], v[128:143]
    s_add_u32 s32, s30, s33
    s_add_u32 s42, s31, s33
    s_add_u32 s33, s33, 4096
    s_cmp_eq_u32 s33, 28672
    s_cselect_b32 s33, 0, s33
    buffer_load_dwordx4 v[16:19], v3, s[16:19], s32 offen offset:0 sc1
    v_mfma_f32_32x32x16_bf16 v[144:159], v[88:91], v[28:31], v[144:159]
    buffer_load_dwordx4 v[20:23], v3, s[16:19], s42 offen offset:0 sc1
    v_mfma_f32_32x32x16_bf16 v[160:175], v[92:95], v[24:27], v[160:175]
    v_mfma_f32_32x32x16_bf16 v[176:191], v[92:95], v[28:31], v[176:191]
    s_waitcnt vmcnt(4)
    v_mfma_f32_32x32x16_bf16 v[128:143], v[96:99], v[240:243], v[128:143]
    buffer_load_dwordx4 v[24:27], v3, s[16:19], s32 offen offset:1024 sc1
    v_mfma_f32_32x32x16_bf16 v[144:159], v[96:99], v[244:247], v[144:159]
    buffer_load_dwordx4 v[28:31], v3, s[16:19], s42 offen offset:1024 sc1
    v_mfma_f32_32x32x16_bf16 v[160:175], v[100:103], v[240:243], v[160:175]
    v_mfma_f32_32x32x16_bf16 v[176:191], v[100:103], v[244:247], v[176:191]
    s_waitcnt vmcnt(4)
    v_mfma_f32_32x32x16_bf16 v[128:143], v[104:107], v[248:251], v[128:143]
    buffer_load_dwordx4 v[240:243], v3, s[16:19], s32 offen offset:2048 sc1
    v_mfma_f32_32x32x16_bf16 v[144:159], v[104:107], v[252:255], v[144:159]
    buffer_load_dwordx4 v[244:247], v3, s[16:19], s42 offen offset:2048 sc1
    v_mfma_f32_32x32x16_bf16 v[160:175], v[108:111], v[248:251], v[160:175]
    v_mfma_f32_32x32x16_bf16 v[176:191], v[108:111], v[252:255], v[176:191]
    s_waitcnt vmcnt(4)
    v_mfma_f32_32x32x16_bf16 v[128:143], v[112:115], v[16:19], v[128:143]
    buffer_load_dwordx4 v[248:251], v3, s[16:19], s32 offen offset:3072 sc1
    v_mfma_f32_32x32x16_bf16 v[144:159], v[112:115], v[20:23], v[144:159]
    buffer_load_dwordx4 v[252:255], v3, s[16:19], s42 offen offset:3072 sc1
    v_mfma_f32_32x32x16_bf16 v[160:175], v[116:119], v[16:19], v[160:175]
    ds_read_b128 v[80:83], v9 offset:16384
    v_mfma_f32_32x32x16_bf16 v[176:191], v[116:119], v[20:23], v[176:191]
    ds_read_b128 v[84:87], v9 offset:17408
    s_waitcnt vmcnt(4)
    v_mfma_f32_32x32x16_bf16 v[128:143], v[120:123], v[24:27], v[128:143]
    s_add_u32 s32, s30, s33
    s_add_u32 s42, s31, s33
    s_add_u32 s33, s33, 4096
    s_cmp_eq_u32 s33, 28672
    s_cselect_b32 s33, 0, s33
    buffer_load_dwordx4 v[16:19], v3, s[16:19], s32 offen offset:0 sc1
    v_mfma_f32_32x32x16_bf16 v[144:159], v[120:123], v[28:31], v[144:159]
    buffer_load_dwordx4 v[20:23], v3, s[16:19], s42 offen offset:0 sc1
    v_mfma_f32_32x32x16_bf16 v[160:175], v[124:127], v[24:27], v[160:175]
    buffer_load_dwordx4 v[112:115], v3, s[16:19], s32 offen offset:1024 sc1
    v_mfma_f32_32x32x16_bf16 v[176:191], v[124:127], v[28:31], v[176:191]
    buffer_load_dwordx4 v[116:119], v3, s[16:19], s42 offen offset:1024 sc1
    ds_read_b128 v[88:91], v9 offset:18432
    ds_read_b128 v[92:95], v9 offset:19456
    s_waitcnt vmcnt(6)
    s_waitcnt lgkmcnt(2)
    v_mfma_f32_32x32x16_bf16 v[128:143], v[80:83], v[240:243], v[128:143]
    buffer_load_dwordx4 v[24:27], v3, s[16:19], s32 offen offset:2048 sc1
    v_mfma_f32_32x32x16_bf16 v[144:159], v[80:83], v[244:247], v[144:159]
    buffer_load_dwordx4 v[28:31], v3, s[16:19], s42 offen offset:2048 sc1
    v_mfma_f32_32x32x16_bf16 v[160:175], v[84:87], v[240:243], v[160:175]
    buffer_load_dwordx4 v[120:123], v3, s[16:19], s32 offen offset:3072 sc1
    v_mfma_f32_32x32x16_bf16 v[176:191], v[84:87], v[244:247], v[176:191]
    buffer_load_dwordx4 v[124:127], v3, s[16:19], s42 offen offset:3072 sc1
    ds_read_b128 v[96:99], v12 offset:0
    ds_read_b128 v[100:103], v12 offset:1024
    s_waitcnt vmcnt(8)
    s_waitcnt lgkmcnt(2)
    v_mfma_f32_32x32x16_bf16 v[128:143], v[88:91], v[248:251], v[128:143]
    s_add_u32 s32, s30, s33
    s_add_u32 s42, s31, s33
    s_add_u32 s33, s33, 4096
    s_cmp_eq_u32 s33, 28672
    s_cselect_b32 s33, 0, s33
    buffer_load_dwordx4 v[240:243], v3, s[16:19], s32 offen offset:0 sc1
    v_mfma_f32_32x32x16_bf16 v[144:159], v[88:91], v[252:255], v[144:159]
    buffer_load_dwordx4 v[244:247], v3, s[16:19], s42 offen offset:0 sc1
    v_mfma_f32_32x32x16_bf16 v[160:175], v[92:95], v[248:251], v[160:175]
    ds_read_b128 v[80:83], v12 offset:2048
    v_mfma_f32_32x32x16_bf16 v[176:191], v[92:95], v[252:255], v[176:191]
    ds_read_b128 v[84:87], v12 offset:3072
    s_waitcnt vmcnt(8)
    s_waitcnt lgkmcnt(2)
    v_mfma_f32_32x32x16_bf16 v[128:143], v[96:99], v[16:19], v[128:143]
    buffer_load_dwordx4 v[248:251], v3, s[16:19], s32 offen offset:1024 sc1
    v_mfma_f32_32x32x16_bf16 v[144:159], v[96:99], v[20:23], v[144:159]
    buffer_load_dwordx4 v[252:255], v3, s[16:19], s42 offen offset:1024 sc1
    v_mfma_f32_32x32x16_bf16 v[160:175], v[100:103], v[16:19], v[160:175]
    ds_read_b128 v[88:91], v9 offset:32768
    v_mfma_f32_32x32x16_bf16 v[176:191], v[100:103], v[20:23], v[176:191]
    ds_read_b128 v[92:95], v9 offset:33792
    s_waitcnt vmcnt(8)
    s_waitcnt lgkmcnt(2)
    v_mfma_f32_32x32x16_bf16 v[128:143], v[80:83], v[112:115], v[128:143]
    buffer_load_dwordx4 v[16:19], v3, s[16:19], s32 offen offset:2048 sc1
    v_mfma_f32_32x32x16_bf16 v[144:159], v[80:83], v[116:119], v[144:159]
    buffer_load_dwordx4 v[20:23], v3, s[16:19], s42 offen offset:2048 sc1
    v_mfma_f32_32x32x16_bf16 v[160:175], v[84:87], v[112:115], v[160:175]
    ds_read_b128 v[96:99], v9 offset:34816
    v_mfma_f32_32x32x16_bf16 v[176:191], v[84:87], v[116:119], v[176:191]
    ds_read_b128 v[100:103], v9 offset:35840
    s_waitcnt vmcnt(8)
    s_waitcnt lgkmcnt(2)
    v_mfma_f32_32x32x16_bf16 v[128:143], v[88:91], v[24:27], v[128:143]
    buffer_load_dwordx4 v[112:115], v3, s[16:19], s32 offen offset:3072 sc1
    v_mfma_f32_32x32x16_bf16 v[144:159], v[88:91], v[28:31], v[144:159]
    buffer_load_dwordx4 v[116:119], v3, s[16:19], s42 offen offset:3072 sc1
    v_mfma_f32_32x32x16_bf16 v[160:175], v[92:95], v[24:27], v[160:175]
    ds_read_b128 v[80:83], v9 offset:0
    v_mfma_f32_32x32x16_bf16 v[176:191], v[92:95], v[28:31], v[176:191]
    ds_read_b128 v[84:87], v9 offset:1024
    s_waitcnt vmcnt(8)
    s_waitcnt lgkmcnt(2)
    v_mfma_f32_32x32x16_bf16 v[128:143], v[96:99], v[120:123], v[128:143]
    s_add_u32 s32, s30, s33
    s_add_u32 s42, s31, s33
    s_add_u32 s33, s33, 4096
    s_cmp_eq_u32 s33, 28672
    s_cselect_b32 s33, 0, s33
    buffer_load_dwordx4 v[24:27], v3, s[16:19], s32 offen offset:0 sc1
    v_mfma_f32_32x32x16_bf16 v[144:159], v[96:99], v[124:127], v[144:159]
    buffer_load_dwordx4 v[28:31], v3, s[16:19], s42 offen offset:0 sc1
    v_mfma_f32_32x32x16_bf16 v[160:175], v[100:103], v[120:123], v[160:175]
    ds_read_b128 v[88:91], v9 offset:2048
    v_mfma_f32_32x32x16_bf16 v[176:191], v[100:103], v[124:127], v[176:191]
    ds_read_b128 v[92:95], v9 offset:3072
    s_waitcnt vmcnt(8)
    s_waitcnt lgkmcnt(2)
    v_mfma_f32_32x32x16_bf16 v[128:143], v[80:83], v[240:243], v[128:143]
    buffer_load_dwordx4 v[120:123], v3, s[16:19], s32 offen offset:1024 sc1
    v_mfma_f32_32x32x16_bf16 v[144:159], v[80:83], v[244:247], v[144:159]
    buffer_load_dwordx4 v[124:127], v3, s[16:19], s42 offen offset:1024 sc1
    v_mfma_f32_32x32x16_bf16 v[160:175], v[84:87], v[240:243], v[160:175]
    ds_read_b128 v[96:99], v9 offset:49152
    v_mfma_f32_32x32x16_bf16 v[176:191], v[84:87], v[244:247], v[176:191]
    ds_read_b128 v[100:103], v9 offset:50176
    s_waitcnt vmcnt(8)
    s_waitcnt lgkmcnt(2)
    v_mfma_f32_32x32x16_bf16 v[128:143], v[88:91], v[248:251], v[128:143]
    buffer_load_dwordx4 v[240:243], v3, s[16:19], s32 offen offset:2048 sc1
    v_mfma_f32_32x32x16_bf16 v[144:159], v[88:91], v[252:255], v[144:159]
    buffer_load_dwordx4 v[244:247], v3, s[16:19], s42 offen offset:2048 sc1
    v_mfma_f32_32x32x16_bf16 v[160:175], v[92:95], v[248:251], v[160:175]
    ds_read_b128 v[80:83], v9 offset:51200
    v_mfma_f32_32x32x16_bf16 v[176:191], v[92:95], v[252:255], v[176:191]
    ds_read_b128 v[84:87], v9 offset:52224
    s_waitcnt vmcnt(8)
    s_waitcnt lgkmcnt(2)
    v_mfma_f32_32x32x16_bf16 v[128:143], v[96:99], v[16:19], v[128:143]
    buffer_load_dwordx4 v[248:251], v3, s[16:19], s32 offen offset:3072 sc1
    v_mfma_f32_32x32x16_bf16 v[144:159], v[96:99], v[20:23], v[144:159]
    buffer_load_dwordx4 v[252:255], v3, s[16:19], s42 offen offset:3072 sc1
    v_mfma_f32_32x32x16_bf16 v[160:175], v[100:103], v[16:19], v[160:175]
    v_mfma_f32_32x32x16_bf16 v[176:191], v[100:103], v[20:23], v[176:191]
    s_waitcnt vmcnt(8)
    s_waitcnt lgkmcnt(0)
    v_mfma_f32_32x32x16_bf16 v[128:143], v[80:83], v[112:115], v[128:143]
    s_add_u32 s32, s30, s33
    s_add_u32 s42, s31, s33
    s_add_u32 s33, s33, 4096
    s_cmp_eq_u32 s33, 28672
    s_cselect_b32 s33, 0, s33
    buffer_load_dwordx4 v[16:19], v3, s[16:19], s32 offen offset:0 sc1
    v_mfma_f32_32x32x16_bf16 v[144:159], v[80:83], v[116:119], v[144:159]
    buffer_load_dwordx4 v[20:23], v3, s[16:19], s42 offen offset:0 sc1
    v_mfma_f32_32x32x16_bf16 v[160:175], v[84:87], v[112:115], v[160:175]
    v_mfma_f32_32x32x16_bf16 v[176:191], v[84:87], v[116:119], v[176:191]
    s_waitcnt vmcnt(8)
    v_mfma_f32_32x32x16_bf16 v[128:143], v[32:35], v[24:27], v[128:143]
    buffer_load_dwordx4 v[112:115], v3, s[16:19], s32 offen offset:1024 sc1
    v_mfma_f32_32x32x16_bf16 v[144:159], v[32:35], v[28:31], v[144:159]
    buffer_load_dwordx4 v[116:119], v3, s[16:19], s42 offen offset:1024 sc1
    v_mfma_f32_32x32x16_bf16 v[160:175], v[36:39], v[24:27], v[160:175]
    v_mfma_f32_32x32x16_bf16 v[176:191], v[36:39], v[28:31], v[176:191]
    s_waitcnt vmcnt(8)
    v_mfma_f32_32x32x16_bf16 v[128:143], v[40:43], v[120:123], v[128:143]
    buffer_load_dwordx4 v[24:27], v3, s[16:19], s32 offen offset:2048 sc1
    v_mfma_f32_32x32x16_bf16 v[144:159], v[40:43], v[124:127], v[144:159]
    buffer_load_dwordx4 v[28:31], v3, s[16:19], s42 offen offset:2048 sc1
    v_mfma_f32_32x32x16_bf16 v[160:175], v[44:47], v[120:123], v[160:175]
    v_mfma_f32_32x32x16_bf16 v[176:191], v[44:47], v[124:127], v[176:191]
    s_waitcnt vmcnt(8)
    v_mfma_f32_32x32x16_bf16 v[128:143], v[48:51], v[240:243], v[128:143]
    buffer_load_dwordx4 v[120:123], v3, s[16:19], s32 offen offset:3072 sc1
    v_mfma_f32_32x32x16_bf16 v[144:159], v[48:51], v[244:247], v[144:159]
    buffer_load_dwordx4 v[124:127], v3, s[16:19], s42 offen offset:3072 sc1
    v_mfma_f32_32x32x16_bf16 v[160:175], v[52:55], v[240:243], v[160:175]
    v_mfma_f32_32x32x16_bf16 v[176:191], v[52:55], v[244:247], v[176:191]
    s_barrier
    s_waitcnt vmcnt(8)
    v_mfma_f32_32x32x16_bf16 v[128:143], v[56:59], v[248:251], v[128:143]
    s_add_u32 s32, s30, s33
    s_add_u32 s42, s31, s33
    s_add_u32 s33, s33, 4096
    s_cmp_eq_u32 s33, 28672
    s_cselect_b32 s33, 0, s33
    buffer_load_dwordx4 v[240:243], v3, s[16:19], s32 offen offset:0 sc1
    v_mfma_f32_32x32x16_bf16 v[144:159], v[56:59], v[252:255], v[144:159]
    buffer_load_dwordx4 v[244:247], v3, s[16:19], s42 offen offset:0 sc1
    v_mfma_f32_32x32x16_bf16 v[160:175], v[60:63], v[248:251], v[160:175]
    v_mfma_f32_32x32x16_bf16 v[176:191], v[60:63], v[252:255], v[176:191]
    s_waitcnt vmcnt(8)
    v_mfma_f32_32x32x16_bf16 v[128:143], v[64:67], v[16:19], v[128:143]
    buffer_load_dwordx4 v[248:251], v3, s[16:19], s32 offen offset:1024 sc1
    v_mfma_f32_32x32x16_bf16 v[144:159], v[64:67], v[20:23], v[144:159]
    buffer_load_dwordx4 v[252:255], v3, s[16:19], s42 offen offset:1024 sc1
    v_mfma_f32_32x32x16_bf16 v[160:175], v[68:71], v[16:19], v[160:175]
    v_mfma_f32_32x32x16_bf16 v[176:191], v[68:71], v[20:23], v[176:191]
    global_load_dword v15, v8, s[52:53] sc1
    s_waitcnt vmcnt(9)
    v_mfma_f32_32x32x16_bf16 v[128:143], v[72:75], v[112:115], v[128:143]
    buffer_load_dwordx4 v[16:19], v3, s[16:19], s32 offen offset:2048 sc1
    v_mfma_f32_32x32x16_bf16 v[144:159], v[72:75], v[116:119], v[144:159]
    buffer_load_dwordx4 v[20:23], v3, s[16:19], s42 offen offset:2048 sc1
    v_mfma_f32_32x32x16_bf16 v[160:175], v[76:79], v[112:115], v[160:175]
    v_mfma_f32_32x32x16_bf16 v[176:191], v[76:79], v[116:119], v[176:191]
    s_waitcnt vmcnt(9)
    v_mfma_f32_32x32x16_bf16 v[128:143], v[192:195], v[24:27], v[128:143]
    buffer_load_dwordx4 v[112:115], v3, s[16:19], s32 offen offset:3072 sc1
    v_mfma_f32_32x32x16_bf16 v[144:159], v[192:195], v[28:31], v[144:159]
    buffer_load_dwordx4 v[116:119], v3, s[16:19], s42 offen offset:3072 sc1
    v_mfma_f32_32x32x16_bf16 v[160:175], v[196:199], v[24:27], v[160:175]
    v_mfma_f32_32x32x16_bf16 v[176:191], v[196:199], v[28:31], v[176:191]
    s_waitcnt vmcnt(9)
    v_mfma_f32_32x32x16_bf16 v[128:143], v[200:203], v[120:123], v[128:143]
    v_mfma_f32_32x32x16_bf16 v[144:159], v[200:203], v[124:127], v[144:159]
    v_mfma_f32_32x32x16_bf16 v[160:175], v[204:207], v[120:123], v[160:175]
    v_mfma_f32_32x32x16_bf16 v[176:191], v[204:207], v[124:127], v[176:191]
    s_waitcnt vmcnt(7)
    v_mfma_f32_32x32x16_bf16 v[128:143], v[208:211], v[240:243], v[128:143]
    v_mfma_f32_32x32x16_bf16 v[144:159], v[208:211], v[244:247], v[144:159]
    v_mfma_f32_32x32x16_bf16 v[160:175], v[212:215], v[240:243], v[160:175]
    v_mfma_f32_32x32x16_bf16 v[176:191], v[212:215], v[244:247], v[176:191]
    s_waitcnt vmcnt(4)
    v_cmp_eq_u32 vcc, s58, v15
    s_nop 3
    s_cmp_eq_u64 vcc, exec
    s_cselect_b32 s29, 1, 0
    buffer_load_dwordx4 v[104:107], v7, s[4:7], s35 offen sc1
    buffer_load_dwordx4 v[108:111], v7, s[4:7], s34 offen sc1
    global_load_dword v11, v6, s[38:39] sc1
    s_waitcnt vmcnt(8)
    v_mfma_f32_32x32x16_bf16 v[128:143], v[216:219], v[248:251], v[128:143]
    v_mfma_f32_32x32x16_bf16 v[144:159], v[216:219], v[252:255], v[144:159]
    v_mfma_f32_32x32x16_bf16 v[160:175], v[220:223], v[248:251], v[160:175]
    v_mfma_f32_32x32x16_bf16 v[176:191], v[220:223], v[252:255], v[176:191]
    s_waitcnt vmcnt(5)
    v_mfma_f32_32x32x16_bf16 v[128:143], v[224:227], v[16:19], v[128:143]
    v_mfma_f32_32x32x16_bf16 v[144:159], v[224:227], v[20:23], v[144:159]
    v_mfma_f32_32x32x16_bf16 v[160:175], v[228:231], v[16:19], v[160:175]
    v_mfma_f32_32x32x16_bf16 v[176:191], v[228:231], v[20:23], v[176:191]
    s_waitcnt vmcnt(3)
    v_mfma_f32_32x32x16_bf16 v[128:143], v[232:235], v[112:115], v[128:143]
    v_mfma_f32_32x32x16_bf16 v[144:159], v[232:235], v[116:119], v[144:159]
    v_mfma_f32_32x32x16_bf16 v[160:175], v[236:239], v[112:115], v[160:175]
    v_mfma_f32_32x32x16_bf16 v[176:191], v[236:239], v[116:119], v[176:191]
    s_xor_b32 s31, s25, 1
    s_mul_i32 s31, s31, 12288
    s_add_u32 s31, s31, 0
    v_add_u32 v10, s31, v3
    s_nop 5
    ds_write_b128 v10, v[144:147] offset:0
    ds_write_b128 v10, v[148:151] offset:1024
    ds_write_b128 v10, v[152:155] offset:2048
    ds_write_b128 v10, v[156:159] offset:3072
    s_xor_b32 s31, s25, 2
    s_mul_i32 s31, s31, 12288
    s_add_u32 s31, s31, 4096
    v_add_u32 v10, s31, v3
    ds_write_b128 v10, v[160:163] offset:0
    ds_write_b128 v10, v[164:167] offset:1024
    ds_write_b128 v10, v[168:171] offset:2048
    ds_write_b128 v10, v[172:175] offset:3072
    s_xor_b32 s31, s25, 3
    s_mul_i32 s31, s31, 12288
    s_add_u32 s31, s31, 8192
    v_add_u32 v10, s31, v3
    ds_write_b128 v10, v[176:179] offset:0
    ds_write_b128 v10, v[180:183] offset:1024
    ds_write_b128 v10, v[184:187] offset:2048
    ds_write_b128 v10, v[188:191] offset:3072
    s_waitcnt vmcnt(0)
    s_cmp_eq_u32 s29, 1
    s_cbranch_scc1 L_g_atok
    s_mov_b32 s59, 30000
L_poll_gat:
    global_load_dword v15, v8, s[52:53] sc1
    s_waitcnt vmcnt(0)
    v_cmp_eq_u32 vcc, s58, v15
    s_nop 3
    s_cmp_eq_u64 vcc, exec
    s_cbranch_scc1 L_poll_done_gat
    s_sleep 1
    s_sub_u32 s59, s59, 1
    s_cmp_lg_u32 s59, 0
    s_cbranch_scc1 L_poll_gat
L_poll_done_gat:
    buffer_load_dwordx4 v[104:107], v7, s[4:7], s35 offen sc1
    buffer_load_dwordx4 v[108:111], v7, s[4:7], s34 offen sc1
    global_load_dword v11, v6, s[38:39] sc1
    s_waitcnt vmcnt(0)
L_g_atok:
    s_lshl_b32 s29, s25, 11
    s_add_u32 s29, s29, 49152
    v_add_u32 v10, s29, v3
    ds_write_b128 v10, v[104:107]
    ds_write_b128 v10, v[108:111] offset:1024
    s_mul_i32 s31, s25, 12288
    v_add_u32 v7, s31, v3
    v_lshrrev_b32 v12, 5, v2
    v_bfe_u32 v13, v2, 2, 2
    v_lshl_add_u32 v13, v12, 2, v13
    s_lshl_b32 s28, s36, 5
    v_add_u32 v13, s28, v13
    v_lshlrev_b32 v13, 7, v13
    v_bfe_u32 v14, v2, 4, 1
    v_lshl_add_u32 v13, v14, 5, v13
    v_and_b32 v14, 3, v2
    v_lshl_add_u32 v13, v14, 3, v13
    s_lshl_b32 s28, s37, 6
    v_add_u32 v13, s28, v13
    v_sub_f32 v14, 1.0, v11
    v_cvt_pk_bf16_f32 v14, 0, v14
    s_waitcnt lgkmcnt(0)
    s_barrier
    ds_read_b128 v[32:35], v7 offset:0
    ds_read_b128 v[36:39], v7 offset:1024
    ds_read_b128 v[40:43], v7 offset:2048
    ds_read_b128 v[44:47], v7 offset:3072
    ds_read_b128 v[48:51], v7 offset:4096
    ds_read_b128 v[52:55], v7 offset:5120
    ds_read_b128 v[56:59], v7 offset:6144
    ds_read_b128 v[60:63], v7 offset:7168
    ds_read_b128 v[64:67], v7 offset:8192
    ds_read_b128 v[68:71], v7 offset:9216
    ds_read_b128 v[72:75], v7 offset:10240
    ds_read_b128 v[76:79], v7 offset:11264
    ds_read_b64_tr_b16 v[112:113], v13 offset:49152
    ds_read_b64_tr_b16 v[114:115], v13 offset:50176
    ds_read_b64_tr_b16 v[116:117], v13 offset:51200
    ds_read_b64_tr_b16 v[118:119], v13 offset:52224
    s_waitcnt lgkmcnt(8)
    v_pk_add_f32 v[128:129], v[128:129], v[32:33]
    v_pk_add_f32 v[130:131], v[130:131], v[34:35]
    v_pk_add_f32 v[132:133], v[132:133], v[36:37]
    v_pk_add_f32 v[134:135], v[134:135], v[38:39]
    v_pk_add_f32 v[136:137], v[136:137], v[40:41]
    v_pk_add_f32 v[138:139], v[138:139], v[42:43]
    v_pk_add_f32 v[140:141], v[140:141], v[44:45]
    v_pk_add_f32 v[142:143], v[142:143], v[46:47]
    s_waitcnt lgkmcnt(4)
    v_pk_add_f32 v[48:49], v[48:49], v[64:65]
    v_pk_add_f32 v[50:51], v[50:51], v[66:67]
    v_pk_add_f32 v[52:53], v[52:53], v[68:69]
    v_pk_add_f32 v[54:55], v[54:55], v[70:71]
    v_pk_add_f32 v[56:57], v[56:57], v[72:73]
    v_pk_add_f32 v[58:59], v[58:59], v[74:75]
    v_pk_add_f32 v[60:61], v[60:61], v[76:77]
    v_pk_add_f32 v[62:63], v[62:63], v[78:79]
    v_pk_add_f32 v[128:129], v[128:129], v[48:49]
    v_pk_add_f32 v[130:131], v[130:131], v[50:51]
    v_pk_add_f32 v[132:133], v[132:133], v[52:53]
    v_pk_add_f32 v[134:135], v[134:135], v[54:55]
    v_pk_add_f32 v[136:137], v[136:137], v[56:57]
    v_pk_add_f32 v[138:139], v[138:139], v[58:59]
    v_pk_add_f32 v[140:141], v[140:141], v[60:61]
    v_pk_add_f32 v[142:143], v[142:143], v[62:63]
    s_waitcnt lgkmcnt(0)
    v_lshlrev_b32 v192, 16, v112
    v_cvt_pk_bf16_f32 v128, 0, v128
    v_mul_f32 v192, v11, v192
    v_mul_f32 v128, v14, v128
    v_cvt_pk_bf16_f32 v192, 0, v192
    v_cvt_pk_bf16_f32 v128, 0, v128
    v_add_f32 v128, v192, v128
    v_and_b32 v193, 0xffff0000, v112
    v_cvt_pk_bf16_f32 v129, 0, v129
    v_mul_f32 v193, v11, v193
    v_mul_f32 v129, v14, v129
    v_cvt_pk_bf16_f32 v193, 0, v193
    v_cvt_pk_bf16_f32 v129, 0, v129
    v_add_f32 v129, v193, v129
    v_lshlrev_b32 v194, 16, v113
    v_cvt_pk_bf16_f32 v130, 0, v130
    v_mul_f32 v194, v11, v194
    v_mul_f32 v130, v14, v130
    v_cvt_pk_bf16_f32 v194, 0, v194
    v_cvt_pk_bf16_f32 v130, 0, v130
    v_add_f32 v130, v194, v130
    v_and_b32 v195, 0xffff0000, v113
    v_cvt_pk_bf16_f32 v131, 0, v131
    v_mul_f32 v195, v11, v195
    v_mul_f32 v131, v14, v131
    v_cvt_pk_bf16_f32 v195, 0, v195
    v_cvt_pk_bf16_f32 v131, 0, v131
    v_add_f32 v131, v195, v131
    v_lshlrev_b32 v196, 16, v114
    v_cvt_pk_bf16_f32 v132, 0, v132
    v_mul_f32 v196, v11, v196
    v_mul_f32 v132, v14, v132
    v_cvt_pk_bf16_f32 v196, 0, v196
    v_cvt_pk_bf16_f32 v132, 0, v132
    v_add_f32 v132, v196, v132
    v_and_b32 v197, 0xffff0000, v114
    v_cvt_pk_bf16_f32 v133, 0, v133
    v_mul_f32 v197, v11, v197
    v_mul_f32 v133, v14, v133
    v_cvt_pk_bf16_f32 v197, 0, v197
    v_cvt_pk_bf16_f32 v133, 0, v133
    v_add_f32 v133, v197, v133
    v_lshlrev_b32 v198, 16, v115
    v_cvt_pk_bf16_f32 v134, 0, v134
    v_mul_f32 v198, v11, v198
    v_mul_f32 v134, v14, v134
    v_cvt_pk_bf16_f32 v198, 0, v198
    v_cvt_pk_bf16_f32 v134, 0, v134
    v_add_f32 v134, v198, v134
    v_and_b32 v199, 0xffff0000, v115
    v_cvt_pk_bf16_f32 v135, 0, v135
    v_mul_f32 v199, v11, v199
    v_mul_f32 v135, v14, v135
    v_cvt_pk_bf16_f32 v199, 0, v199
    v_cvt_pk_bf16_f32 v135, 0, v135
    v_add_f32 v135, v199, v135
    v_lshlrev_b32 v200, 16, v116
    v_cvt_pk_bf16_f32 v136, 0, v136
    v_mul_f32 v200, v11, v200
    v_mul_f32 v136, v14, v136
    v_cvt_pk_bf16_f32 v200, 0, v200
    v_cvt_pk_bf16_f32 v136, 0, v136
    v_add_f32 v136, v200, v136
    v_and_b32 v201, 0xffff0000, v116
    v_cvt_pk_bf16_f32 v137, 0, v137
    v_mul_f32 v201, v11, v201
    v_mul_f32 v137, v14, v137
    v_cvt_pk_bf16_f32 v201, 0, v201
    v_cvt_pk_bf16_f32 v137, 0, v137
    v_add_f32 v137, v201, v137
    v_lshlrev_b32 v202, 16, v117
    v_cvt_pk_bf16_f32 v138, 0, v138
    v_mul_f32 v202, v11, v202
    v_mul_f32 v138, v14, v138
    v_cvt_pk_bf16_f32 v202, 0, v202
    v_cvt_pk_bf16_f32 v138, 0, v138
    v_add_f32 v138, v202, v138
    v_and_b32 v203, 0xffff0000, v117
    v_cvt_pk_bf16_f32 v139, 0, v139
    v_mul_f32 v203, v11, v203
    v_mul_f32 v139, v14, v139
    v_cvt_pk_bf16_f32 v203, 0, v203
    v_cvt_pk_bf16_f32 v139, 0, v139
    v_add_f32 v139, v203, v139
    v_lshlrev_b32 v204, 16, v118
    v_cvt_pk_bf16_f32 v140, 0, v140
    v_mul_f32 v204, v11, v204
    v_mul_f32 v140, v14, v140
    v_cvt_pk_bf16_f32 v204, 0, v204
    v_cvt_pk_bf16_f32 v140, 0, v140
    v_add_f32 v140, v204, v140
    v_and_b32 v205, 0xffff0000, v118
    v_cvt_pk_bf16_f32 v141, 0, v141
    v_mul_f32 v205, v11, v205
    v_mul_f32 v141, v14, v141
    v_cvt_pk_bf16_f32 v205, 0, v205
    v_cvt_pk_bf16_f32 v141, 0, v141
    v_add_f32 v141, v205, v141
    v_lshlrev_b32 v206, 16, v119
    v_cvt_pk_bf16_f32 v142, 0, v142
    v_mul_f32 v206, v11, v206
    v_mul_f32 v142, v14, v142
    v_cvt_pk_bf16_f32 v206, 0, v206
    v_cvt_pk_bf16_f32 v142, 0, v142
    v_add_f32 v142, v206, v142
    v_and_b32 v207, 0xffff0000, v119
    v_cvt_pk_bf16_f32 v143, 0, v143
    v_mul_f32 v207, v11, v207
    v_mul_f32 v143, v14, v143
    v_cvt_pk_bf16_f32 v207, 0, v207
    v_cvt_pk_bf16_f32 v143, 0, v143
    v_add_f32 v143, v207, v143
    v_cvt_pk_bf16_f32 v32, v128, v129
    v_cvt_pk_bf16_f32 v33, v130, v131
    v_cvt_pk_bf16_f32 v34, v132, v133
    v_cvt_pk_bf16_f32 v35, v134, v135
    v_cvt_pk_bf16_f32 v36, v136, v137
    v_cvt_pk_bf16_f32 v37, v138, v139
    v_cvt_pk_bf16_f32 v38, v140, v141
    v_cvt_pk_bf16_f32 v39, v142, v143
    s_nop 1
    v_permlane32_swap_b32 v32, v34
    v_permlane32_swap_b32 v33, v35
    v_permlane32_swap_b32 v36, v38
    v_permlane32_swap_b32 v37, v39
    v_mul_u32_u24 v5, 896, v5
    s_lshl_b32 s28, s43, 7
    s_lshl_b32 s29, s36, 6
    s_add_u32 s28, s28, s29
    v_lshl_add_u32 v5, v12, 4, v5
    v_add_u32 v5, s28, v5
    global_store_dwordx4 v5, v[32:35], s[44:45]
    global_store_dwordx4 v5, v[36:39], s[44:45] offset:32
    s_endpgm
L_s:
    s_setprio 2
    s_sub_u32 s20, s2, 256
    s_load_dwordx4 s[4:7], s[0:1], 8
    s_load_dwordx4 s[8:11], s[0:1], 24
    s_load_dwordx4 s[12:15], s[0:1], 40
    s_load_dwordx4 s[16:19], s[0:1], 56
    s_load_dwordx2 s[44:45], s[0:1], 0
    s_load_dwordx4 s[48:51], s[0:1], 120
    v_lshrrev_b32 v1, 6, v0
    v_and_b32 v2, 63, v0
    v_readfirstlane_b32 s21, v1
    s_lshl_b32 s22, s20, 2
    v_lshrrev_b32 v13, 3, v2
    v_mul_u32_u24 v13, 896, v13
    v_and_b32 v14, 7, v2
    v_lshl_add_u32 v13, v14, 4, v13
    s_lshr_b32 s32, s20, 5
    s_and_b32 s33, s20, 31
    s_lshl_b32 s34, s33, 6
    s_lshl_b32 s35, s21, 4
    s_add_u32 s34, s34, s35
    s_mul_i32 s34, s34, 896
    s_lshl_b32 s35, s32, 7
    s_add_u32 s34, s34, s35
    s_mul_i32 s35, s21, 2080
    s_add_u32 s35, s35, 68096
    s_mov_b32 s46, 1835008
    s_mov_b32 s47, 0x20000
    s_lshr_b32 s23, s21, 1
    s_and_b32 s24, s21, 1
    s_lshl_b32 s25, s20, 1
    s_add_u32 s25, s25, s23
    s_lshl_b32 s26, s25, 9
    s_lshl_b32 s27, s24, 8
    s_add_u32 s26, s26, s27
    v_lshl_add_u32 v3, v2, 2, s26
    v_mov_b32 v249, v13
    v_mov_b32 v13, v249
    s_waitcnt lgkmcnt(0)
    s_mov_b32 m0, s35
    s_load_dword s28, s[16:17], s22
    s_load_dword s29, s[18:19], s22
    buffer_load_dwordx4 v13, s[44:47], s34 offen lds
    s_add_u32 s34, s34, 7168
    s_add_u32 m0, m0, 1040
    s_nop 0
    buffer_load_dwordx4 v13, s[44:47], s34 offen lds
    v_mov_b32 v48, 0
    global_load_dword v49, v48, s[48:49] sc1
    global_load_dword v4, v3, s[4:5]
    global_load_dword v5, v3, s[6:7]
    global_load_dword v6, v3, s[8:9]
    global_load_dword v7, v3, s[10:11]
    global_load_dword v8, v3, s[12:13]
    global_load_dword v9, v3, s[14:15]
    s_add_u32 s52, s50, 10092544
    s_addc_u32 s53, s51, 0
    v_lshlrev_b32 v14, 3, v0
    v_sub_u32 v14, 2047, v14
    v_subrev_u32 v15, 0, v14
    v_cvt_f32_u32 v15, v15
    v_cvt_pk_bf16_f32 v15, 0, v15
    v_cvt_u32_f32 v15, v15
    v_lshrrev_b32 v16, 8, v15
    v_lshlrev_b32 v17, 3, v16
    v_lshl_add_u32 v18, v16, 2, 4
    v_lshl_add_u32 v19, v16, 1, 8
    v_min_u32 v17, v17, v18
    v_add_u32 v18, 12, v16
    v_min3_u32 v17, v17, v18, v19
    v_min_u32 v16, 2, v16
    v_and_b32 v18, 7, v15
    v_lshrrev_b32 v18, v16, v18
    v_add_u32 v17, v17, v18
    v_bfe_u32 v18, v15, 3, 5
    v_lshlrev_b32 v18, 1, v18
    v_lshl_add_u32 v200, v17, 6, v18
    v_add_u32 v200, 77312, v200
    v_subrev_u32 v15, 1, v14
    v_cvt_f32_u32 v15, v15
    v_cvt_pk_bf16_f32 v15, 0, v15
    v_cvt_u32_f32 v15, v15
    v_lshrrev_b32 v16, 8, v15
    v_lshlrev_b32 v17, 3, v16
    v_lshl_add_u32 v18, v16, 2, 4
    v_lshl_add_u32 v19, v16, 1, 8
    v_min_u32 v17, v17, v18
    v_add_u32 v18, 12, v16
    v_min3_u32 v17, v17, v18, v19
    v_min_u32 v16, 2, v16
    v_and_b32 v18, 7, v15
    v_lshrrev_b32 v18, v16, v18
    v_add_u32 v17, v17, v18
    v_bfe_u32 v18, v15, 3, 5
    v_lshlrev_b32 v18, 1, v18
    v_lshl_add_u32 v201, v17, 6, v18
    v_add_u32 v201, 77312, v201
    v_subrev_u32 v15, 2, v14
    v_cvt_f32_u32 v15, v15
    v_cvt_pk_bf16_f32 v15, 0, v15
    v_cvt_u32_f32 v15, v15
    v_lshrrev_b32 v16, 8, v15
    v_lshlrev_b32 v17, 3, v16
    v_lshl_add_u32 v18, v16, 2, 4
    v_lshl_add_u32 v19, v16, 1, 8
    v_min_u32 v17, v17, v18
    v_add_u32 v18, 12, v16
    v_min3_u32 v17, v17, v18, v19
    v_min_u32 v16, 2, v16
    v_and_b32 v18, 7, v15
    v_lshrrev_b32 v18, v16, v18
    v_add_u32 v17, v17, v18
    v_bfe_u32 v18, v15, 3, 5
    v_lshlrev_b32 v18, 1, v18
    v_lshl_add_u32 v202, v17, 6, v18
    v_add_u32 v202, 77312, v202
    v_subrev_u32 v15, 3, v14
    v_cvt_f32_u32 v15, v15
    v_cvt_pk_bf16_f32 v15, 0, v15
    v_cvt_u32_f32 v15, v15
    v_lshrrev_b32 v16, 8, v15
    v_lshlrev_b32 v17, 3, v16
    v_lshl_add_u32 v18, v16, 2, 4
    v_lshl_add_u32 v19, v16, 1, 8
    v_min_u32 v17, v17, v18
    v_add_u32 v18, 12, v16
    v_min3_u32 v17, v17, v18, v19
    v_min_u32 v16, 2, v16
    v_and_b32 v18, 7, v15
    v_lshrrev_b32 v18, v16, v18
    v_add_u32 v17, v17, v18
    v_bfe_u32 v18, v15, 3, 5
    v_lshlrev_b32 v18, 1, v18
    v_lshl_add_u32 v203, v17, 6, v18
    v_add_u32 v203, 77312, v203
    v_subrev_u32 v15, 4, v14
    v_cvt_f32_u32 v15, v15
    v_cvt_pk_bf16_f32 v15, 0, v15
    v_cvt_u32_f32 v15, v15
    v_lshrrev_b32 v16, 8, v15
    v_lshlrev_b32 v17, 3, v16
    v_lshl_add_u32 v18, v16, 2, 4
    v_lshl_add_u32 v19, v16, 1, 8
    v_min_u32 v17, v17, v18
    v_add_u32 v18, 12, v16
    v_min3_u32 v17, v17, v18, v19
    v_min_u32 v16, 2, v16
    v_and_b32 v18, 7, v15
    v_lshrrev_b32 v18, v16, v18
    v_add_u32 v17, v17, v18
    v_bfe_u32 v18, v15, 3, 5
    v_lshlrev_b32 v18, 1, v18
    v_lshl_add_u32 v204, v17, 6, v18
    v_add_u32 v204, 77312, v204
    v_subrev_u32 v15, 5, v14
    v_cvt_f32_u32 v15, v15
    v_cvt_pk_bf16_f32 v15, 0, v15
    v_cvt_u32_f32 v15, v15
    v_lshrrev_b32 v16, 8, v15
    v_lshlrev_b32 v17, 3, v16
    v_lshl_add_u32 v18, v16, 2, 4
    v_lshl_add_u32 v19, v16, 1, 8
    v_min_u32 v17, v17, v18
    v_add_u32 v18, 12, v16
    v_min3_u32 v17, v17, v18, v19
    v_min_u32 v16, 2, v16
    v_and_b32 v18, 7, v15
    v_lshrrev_b32 v18, v16, v18
    v_add_u32 v17, v17, v18
    v_bfe_u32 v18, v15, 3, 5
    v_lshlrev_b32 v18, 1, v18
    v_lshl_add_u32 v205, v17, 6, v18
    v_add_u32 v205, 77312, v205
    v_subrev_u32 v15, 6, v14
    v_cvt_f32_u32 v15, v15
    v_cvt_pk_bf16_f32 v15, 0, v15
    v_cvt_u32_f32 v15, v15
    v_lshrrev_b32 v16, 8, v15
    v_lshlrev_b32 v17, 3, v16
    v_lshl_add_u32 v18, v16, 2, 4
    v_lshl_add_u32 v19, v16, 1, 8
    v_min_u32 v17, v17, v18
    v_add_u32 v18, 12, v16
    v_min3_u32 v17, v17, v18, v19
    v_min_u32 v16, 2, v16
    v_and_b32 v18, 7, v15
    v_lshrrev_b32 v18, v16, v18
    v_add_u32 v17, v17, v18
    v_bfe_u32 v18, v15, 3, 5
    v_lshlrev_b32 v18, 1, v18
    v_lshl_add_u32 v206, v17, 6, v18
    v_add_u32 v206, 77312, v206
    v_subrev_u32 v15, 7, v14
    v_cvt_f32_u32 v15, v15
    v_cvt_pk_bf16_f32 v15, 0, v15
    v_cvt_u32_f32 v15, v15
    v_lshrrev_b32 v16, 8, v15
    v_lshlrev_b32 v17, 3, v16
    v_lshl_add_u32 v18, v16, 2, 4
    v_lshl_add_u32 v19, v16, 1, 8
    v_min_u32 v17, v17, v18
    v_add_u32 v18, 12, v16
    v_min3_u32 v17, v17, v18, v19
    v_min_u32 v16, 2, v16
    v_and_b32 v18, 7, v15
    v_lshrrev_b32 v18, v16, v18
    v_add_u32 v17, v17, v18
    v_bfe_u32 v18, v15, 3, 5
    v_lshlrev_b32 v18, 1, v18
    v_lshl_add_u32 v207, v17, 6, v18
    v_add_u32 v207, 77312, v207
    v_and_b32 v14, 7, v2
    v_lshrrev_b32 v15, 3, v2
    s_lshl_b32 s31, s21, 3
    v_add_u32 v15, s31, v15
    v_mul_u32_u24 v13, 1040, v14
    v_lshl_add_u32 v13, v15, 2, v13
    v_add_u32 v13, 68096, v13
    s_lshl_b32 s31, s32, 5
    v_add_u32 v15, s31, v15
    v_lshlrev_b32 v15, 13, v15
    v_lshl_add_u32 v15, v14, 4, v15
    s_lshl_b32 s31, s33, 7
    v_add_u32 v15, s31, v15
    s_add_u32 s54, s50, 10485760
    s_addc_u32 s55, s51, 0
    s_mov_b32 s34, 0x05040100
    s_mov_b32 s35, 0x07060302
    s_waitcnt vmcnt(7)
    s_barrier
    ds_read_b32 v32, v13 offset:0
    ds_read_b32 v33, v13 offset:128
    ds_read_b32 v34, v13 offset:256
    ds_read_b32 v35, v13 offset:384
    ds_read_b32 v36, v13 offset:512
    ds_read_b32 v37, v13 offset:640
    ds_read_b32 v38, v13 offset:768
    ds_read_b32 v39, v13 offset:896
    s_waitcnt lgkmcnt(0)
    v_perm_b32 v40, v33, v32, s34
    v_perm_b32 v44, v33, v32, s35
    v_perm_b32 v41, v35, v34, s34
    v_perm_b32 v45, v35, v34, s35
    v_perm_b32 v42, v37, v36, s34
    v_perm_b32 v46, v37, v36, s35
    v_perm_b32 v43, v39, v38, s34
    v_perm_b32 v47, v39, v38, s35
    global_store_dwordx4 v15, v[40:43], s[54:55] sc1
    v_add_u32 v14, 4096, v15
    global_store_dwordx4 v14, v[44:47], s[54:55] sc1
    s_setprio 0
    s_lshl_b32 s31, s28, 16
    s_and_b32 s28, s28, 0xffff0000
    s_cmp_eq_u32 s23, 0
    s_cselect_b32 s28, s31, s28
    s_lshl_b32 s31, s29, 16
    s_and_b32 s29, s29, 0xffff0000
    s_cmp_eq_u32 s23, 0
    s_cselect_b32 s29, s31, s29
    v_mov_b32 v12, s28
    v_mul_f32 v12, 0x3fb8aa3b, v12
    v_exp_f32 v12, v12
    s_nop 0
    v_cvt_pk_bf16_f32 v12, 0, v12
    s_mul_i32 s30, s21, 8704
    v_and_b32 v10, 31, v2
    v_mul_u32_u24 v10, 272, v10
    v_lshrrev_b32 v11, 5, v2
    v_lshl_add_u32 v10, v11, 4, v10
    v_add_u32 v10, s30, v10
    s_waitcnt vmcnt(2)
    s_setprio 0
    v_mov_b32 v16, 0
    v_mov_b32 v17, 0
    v_mov_b32 v18, 0
    v_mov_b32 v19, 0
    v_mov_b32 v20, 0
    v_mov_b32 v21, 0
    v_mov_b32 v22, 0
    v_mov_b32 v23, 0
    v_mov_b32 v24, 0
    v_mov_b32 v25, 0
    v_mov_b32 v26, 0
    v_mov_b32 v27, 0
    v_mov_b32 v28, 0
    v_mov_b32 v29, 0
    v_mov_b32 v30, 0
    v_mov_b32 v31, 0
    s_mov_b32 s31, 2
L_kg_round:
    v_lshlrev_b32 v80, 16, v4
    v_lshlrev_b32 v81, 16, v5
    v_lshlrev_b32 v52, 16, v6
    v_lshlrev_b32 v53, 16, v7
    v_lshlrev_b32 v54, 16, v8
    v_lshlrev_b32 v55, 16, v9
    v_mul_f32 v80, v12, v80
    v_mul_f32 v81, v12, v81
    v_mul_f32 v52, v12, v52
    v_mul_f32 v53, v12, v53
    v_mul_f32 v80, 0x3fb8aa3b, v80
    v_mul_f32 v81, 0.15915494, v81
    v_mul_f32 v64, v55, v53
    v_mul_f32 v65, v55, v52
    v_fma_f32 v57, v54, v53, v65
    v_fma_f32 v56, v54, v52, -v64
    v_fract_f32 v83, v81
    v_exp_f32 v82, v80
    v_cos_f32 v58, v83
    v_sin_f32 v59, v83
    v_mul_f32 v58, v82, v58
    v_mul_f32 v59, v82, v59
    v_mul_f32 v82, 0x41000000, v80
    v_mul_f32 v83, 0x41000000, v81
    v_fract_f32 v83, v83
    v_exp_f32 v82, v82
    v_cos_f32 v60, v83
    v_sin_f32 v61, v83
    v_mul_f32 v60, v82, v60
    v_mul_f32 v61, v82, v61
    v_mul_f32 v82, 0x43800000, v80
    v_mul_f32 v83, 0x43800000, v81
    v_fract_f32 v83, v83
    v_exp_f32 v82, v82
    v_cos_f32 v62, v83
    v_sin_f32 v63, v83
    v_mul_f32 v62, v82, v62
    v_mul_f32 v63, v82, v63
    v_lshrrev_b32 v4, 16, v4
    v_lshrrev_b32 v5, 16, v5
    v_lshrrev_b32 v6, 16, v6
    v_lshrrev_b32 v7, 16, v7
    v_lshrrev_b32 v8, 16, v8
    v_lshrrev_b32 v9, 16, v9
    s_mov_b32 m0, s30
    v_cvt_pk_bf16_f32 v84, v56, -v57
    ds_write_addtid_b32 v84 offset:0
    v_mul_f32 v64, v57, v59
    v_mul_f32 v65, v57, v58
    v_fma_f32 v67, v56, v59, v65
    v_fma_f32 v66, v56, v58, -v64
    v_mul_f32 v78, v61, v61
    v_mul_f32 v79, v61, v60
    v_fma_f32 v69, v60, v61, v79
    v_fma_f32 v68, v60, v60, -v78
    v_cvt_pk_bf16_f32 v85, v66, -v67
    ds_write_addtid_b32 v85 offset:272
    v_mul_f32 v90, v67, v59
    v_mul_f32 v91, v67, v58
    v_fma_f32 v71, v66, v59, v91
    v_fma_f32 v70, v66, v58, -v90
    v_cvt_pk_bf16_f32 v86, v70, -v71
    ds_write_addtid_b32 v86 offset:544
    v_mul_f32 v64, v71, v59
    v_mul_f32 v65, v71, v58
    v_fma_f32 v67, v70, v59, v65
    v_fma_f32 v66, v70, v58, -v64
    v_cvt_pk_bf16_f32 v87, v66, -v67
    ds_write_addtid_b32 v87 offset:816
    v_mul_f32 v90, v67, v59
    v_mul_f32 v91, v67, v58
    v_fma_f32 v73, v66, v59, v91
    v_fma_f32 v72, v66, v58, -v90
    v_cvt_pk_bf16_f32 v84, v72, -v73
    ds_write_addtid_b32 v84 offset:1088
    v_mul_f32 v64, v73, v59
    v_mul_f32 v65, v73, v58
    v_fma_f32 v67, v72, v59, v65
    v_fma_f32 v66, v72, v58, -v64
    v_cvt_pk_bf16_f32 v85, v66, -v67
    ds_write_addtid_b32 v85 offset:1360
    v_mul_f32 v90, v67, v59
    v_mul_f32 v91, v67, v58
    v_fma_f32 v75, v66, v59, v91
    v_fma_f32 v74, v66, v58, -v90
    v_cvt_pk_bf16_f32 v86, v74, -v75
    ds_write_addtid_b32 v86 offset:1632
    v_mul_f32 v64, v75, v59
    v_mul_f32 v65, v75, v58
    v_fma_f32 v67, v74, v59, v65
    v_fma_f32 v66, v74, v58, -v64
    v_cvt_pk_bf16_f32 v87, v66, -v67
    ds_write_addtid_b32 v87 offset:1904
    v_mul_f32 v90, v57, v63
    v_mul_f32 v91, v57, v62
    v_fma_f32 v57, v56, v63, v91
    v_fma_f32 v56, v56, v62, -v90
    v_cvt_pk_bf16_f32 v84, v56, -v57
    ds_write_addtid_b32 v84 offset:2176
    v_mul_f32 v64, v71, v63
    v_mul_f32 v65, v71, v62
    v_fma_f32 v71, v70, v63, v65
    v_fma_f32 v70, v70, v62, -v64
    v_cvt_pk_bf16_f32 v85, v70, -v71
    ds_write_addtid_b32 v85 offset:2448
    v_mul_f32 v90, v73, v63
    v_mul_f32 v91, v73, v62
    v_fma_f32 v73, v72, v63, v91
    v_fma_f32 v72, v72, v62, -v90
    v_cvt_pk_bf16_f32 v86, v72, -v73
    ds_write_addtid_b32 v86 offset:2720
    v_mul_f32 v64, v75, v63
    v_mul_f32 v65, v75, v62
    v_fma_f32 v75, v74, v63, v65
    v_fma_f32 v74, v74, v62, -v64
    v_cvt_pk_bf16_f32 v87, v74, -v75
    ds_write_addtid_b32 v87 offset:2992
    v_mul_f32 v90, v57, v63
    v_mul_f32 v91, v57, v62
    v_fma_f32 v57, v56, v63, v91
    v_fma_f32 v56, v56, v62, -v90
    v_cvt_pk_bf16_f32 v84, v56, -v57
    ds_write_addtid_b32 v84 offset:3264
    v_mul_f32 v64, v73, v63
    v_mul_f32 v65, v73, v62
    v_fma_f32 v73, v72, v63, v65
    v_fma_f32 v72, v72, v62, -v64
    v_cvt_pk_bf16_f32 v85, v72, -v73
    ds_write_addtid_b32 v85 offset:3536
    v_mul_f32 v90, v57, v63
    v_mul_f32 v91, v57, v62
    v_fma_f32 v57, v56, v63, v91
    v_fma_f32 v56, v56, v62, -v90
    v_cvt_pk_bf16_f32 v86, v56, -v57
    ds_write_addtid_b32 v86 offset:3808
    v_mul_f32 v64, v73, v63
    v_mul_f32 v65, v73, v62
    v_fma_f32 v73, v72, v63, v65
    v_fma_f32 v72, v72, v62, -v64
    v_cvt_pk_bf16_f32 v87, v72, -v73
    ds_write_addtid_b32 v87 offset:4080
    v_mul_f32 v90, v57, v63
    v_mul_f32 v91, v57, v62
    v_fma_f32 v57, v56, v63, v91
    v_fma_f32 v56, v56, v62, -v90
    v_cvt_pk_bf16_f32 v84, v56, -v57
    ds_write_addtid_b32 v84 offset:4352
    v_mul_f32 v64, v57, v63
    v_mul_f32 v65, v57, v62
    v_fma_f32 v57, v56, v63, v65
    v_fma_f32 v56, v56, v62, -v64
    v_cvt_pk_bf16_f32 v85, v56, -v57
    ds_write_addtid_b32 v85 offset:4624
    v_mul_f32 v90, v57, v63
    v_mul_f32 v91, v57, v62
    v_fma_f32 v57, v56, v63, v91
    v_fma_f32 v56, v56, v62, -v90
    v_cvt_pk_bf16_f32 v86, v56, -v57
    ds_write_addtid_b32 v86 offset:4896
    v_mul_f32 v64, v57, v63
    v_mul_f32 v65, v57, v62
    v_fma_f32 v57, v56, v63, v65
    v_fma_f32 v56, v56, v62, -v64
    v_cvt_pk_bf16_f32 v87, v56, -v57
    ds_write_addtid_b32 v87 offset:5168
    v_mul_f32 v90, v57, v63
    v_mul_f32 v91, v57, v62
    v_fma_f32 v57, v56, v63, v91
    v_fma_f32 v56, v56, v62, -v90
    v_cvt_pk_bf16_f32 v84, v56, -v57
    ds_write_addtid_b32 v84 offset:5440
    ds_read_b128 v[96:99], v10 offset:0
    ds_read_b128 v[100:103], v10 offset:32
    ds_read_b128 v[104:107], v10 offset:64
    ds_read_b128 v[108:111], v10 offset:96
    ds_read_b128 v[112:115], v10 offset:128
    ds_read_b128 v[116:119], v10 offset:160
    ds_read_b128 v[120:123], v10 offset:192
    ds_read_b128 v[124:127], v10 offset:224
    v_mov_b32 v88, 1.0
    v_mov_b32 v89, 0
    v_mov_b32 v76, v60
    v_mov_b32 v77, v61
    v_cvt_pk_bf16_f32 v85, v88, v89
    ds_write_addtid_b32 v85 offset:0
    v_cvt_pk_bf16_f32 v86, v76, v77
    ds_write_addtid_b32 v86 offset:272
    v_mul_f32 v64, v89, v69
    v_mul_f32 v65, v89, v68
    v_fma_f32 v89, v88, v69, v65
    v_fma_f32 v88, v88, v68, -v64
    v_mul_f32 v78, v77, v69
    v_mul_f32 v79, v77, v68
    v_fma_f32 v77, v76, v69, v79
    v_fma_f32 v76, v76, v68, -v78
    v_cvt_pk_bf16_f32 v87, v88, v89
    ds_write_addtid_b32 v87 offset:544
    v_cvt_pk_bf16_f32 v84, v76, v77
    ds_write_addtid_b32 v84 offset:816
    v_mul_f32 v64, v89, v69
    v_mul_f32 v65, v89, v68
    v_fma_f32 v89, v88, v69, v65
    v_fma_f32 v88, v88, v68, -v64
    v_mul_f32 v78, v77, v69
    v_mul_f32 v79, v77, v68
    v_fma_f32 v77, v76, v69, v79
    v_fma_f32 v76, v76, v68, -v78
    v_cvt_pk_bf16_f32 v85, v88, v89
    ds_write_addtid_b32 v85 offset:1088
    v_cvt_pk_bf16_f32 v86, v76, v77
    ds_write_addtid_b32 v86 offset:1360
    v_mul_f32 v64, v89, v69
    v_mul_f32 v65, v89, v68
    v_fma_f32 v89, v88, v69, v65
    v_fma_f32 v88, v88, v68, -v64
    v_mul_f32 v78, v77, v69
    v_mul_f32 v79, v77, v68
    v_fma_f32 v77, v76, v69, v79
    v_fma_f32 v76, v76, v68, -v78
    v_cvt_pk_bf16_f32 v87, v88, v89
    ds_write_addtid_b32 v87 offset:1632
    v_cvt_pk_bf16_f32 v84, v76, v77
    ds_write_addtid_b32 v84 offset:1904
    v_mul_f32 v64, v89, v69
    v_mul_f32 v65, v89, v68
    v_fma_f32 v89, v88, v69, v65
    v_fma_f32 v88, v88, v68, -v64
    v_mul_f32 v78, v77, v69
    v_mul_f32 v79, v77, v68
    v_fma_f32 v77, v76, v69, v79
    v_fma_f32 v76, v76, v68, -v78
    v_cvt_pk_bf16_f32 v85, v88, v89
    ds_write_addtid_b32 v85 offset:2176
    v_cvt_pk_bf16_f32 v86, v76, v77
    ds_write_addtid_b32 v86 offset:2448
    v_mul_f32 v64, v89, v69
    v_mul_f32 v65, v89, v68
    v_fma_f32 v89, v88, v69, v65
    v_fma_f32 v88, v88, v68, -v64
    v_mul_f32 v78, v77, v69
    v_mul_f32 v79, v77, v68
    v_fma_f32 v77, v76, v69, v79
    v_fma_f32 v76, v76, v68, -v78
    v_cvt_pk_bf16_f32 v87, v88, v89
    ds_write_addtid_b32 v87 offset:2720
    v_cvt_pk_bf16_f32 v84, v76, v77
    ds_write_addtid_b32 v84 offset:2992
    v_mul_f32 v64, v89, v69
    v_mul_f32 v65, v89, v68
    v_fma_f32 v89, v88, v69, v65
    v_fma_f32 v88, v88, v68, -v64
    v_mul_f32 v78, v77, v69
    v_mul_f32 v79, v77, v68
    v_fma_f32 v77, v76, v69, v79
    v_fma_f32 v76, v76, v68, -v78
    v_cvt_pk_bf16_f32 v85, v88, v89
    ds_write_addtid_b32 v85 offset:3264
    v_cvt_pk_bf16_f32 v86, v76, v77
    ds_write_addtid_b32 v86 offset:3536
    v_mul_f32 v64, v89, v69
    v_mul_f32 v65, v89, v68
    v_fma_f32 v89, v88, v69, v65
    v_fma_f32 v88, v88, v68, -v64
    v_mul_f32 v78, v77, v69
    v_mul_f32 v79, v77, v68
    v_fma_f32 v77, v76, v69, v79
    v_fma_f32 v76, v76, v68, -v78
    v_cvt_pk_bf16_f32 v87, v88, v89
    ds_write_addtid_b32 v87 offset:3808
    v_cvt_pk_bf16_f32 v84, v76, v77
    ds_write_addtid_b32 v84 offset:4080
    v_mul_f32 v64, v89, v69
    v_mul_f32 v65, v89, v68
    v_fma_f32 v89, v88, v69, v65
    v_fma_f32 v88, v88, v68, -v64
    v_mul_f32 v78, v77, v69
    v_mul_f32 v79, v77, v68
    v_fma_f32 v77, v76, v69, v79
    v_fma_f32 v76, v76, v68, -v78
    v_cvt_pk_bf16_f32 v85, v88, v89
    ds_write_addtid_b32 v85 offset:4352
    v_cvt_pk_bf16_f32 v86, v76, v77
    ds_write_addtid_b32 v86 offset:4624
    v_mul_f32 v64, v89, v69
    v_mul_f32 v65, v89, v68
    v_fma_f32 v89, v88, v69, v65
    v_fma_f32 v88, v88, v68, -v64
    v_mul_f32 v78, v77, v69
    v_mul_f32 v79, v77, v68
    v_fma_f32 v77, v76, v69, v79
    v_fma_f32 v76, v76, v68, -v78
    v_cvt_pk_bf16_f32 v87, v88, v89
    ds_write_addtid_b32 v87 offset:4896
    v_cvt_pk_bf16_f32 v84, v76, v77
    ds_write_addtid_b32 v84 offset:5168
    v_mul_f32 v64, v89, v69
    v_mul_f32 v65, v89, v68
    v_fma_f32 v89, v88, v69, v65
    v_fma_f32 v88, v88, v68, -v64
    v_mul_f32 v78, v77, v69
    v_mul_f32 v79, v77, v68
    v_fma_f32 v77, v76, v69, v79
    v_fma_f32 v76, v76, v68, -v78
    v_cvt_pk_bf16_f32 v85, v88, v89
    ds_write_addtid_b32 v85 offset:5440
    v_cvt_pk_bf16_f32 v86, v76, v77
    ds_write_addtid_b32 v86 offset:5712
    v_mul_f32 v64, v89, v69
    v_mul_f32 v65, v89, v68
    v_fma_f32 v89, v88, v69, v65
    v_fma_f32 v88, v88, v68, -v64
    v_mul_f32 v78, v77, v69
    v_mul_f32 v79, v77, v68
    v_fma_f32 v77, v76, v69, v79
    v_fma_f32 v76, v76, v68, -v78
    v_cvt_pk_bf16_f32 v87, v88, v89
    ds_write_addtid_b32 v87 offset:5984
    v_cvt_pk_bf16_f32 v84, v76, v77
    ds_write_addtid_b32 v84 offset:6256
    v_mul_f32 v64, v89, v69
    v_mul_f32 v65, v89, v68
    v_fma_f32 v89, v88, v69, v65
    v_fma_f32 v88, v88, v68, -v64
    v_mul_f32 v78, v77, v69
    v_mul_f32 v79, v77, v68
    v_fma_f32 v77, v76, v69, v79
    v_fma_f32 v76, v76, v68, -v78
    v_cvt_pk_bf16_f32 v85, v88, v89
    ds_write_addtid_b32 v85 offset:6528
    v_cvt_pk_bf16_f32 v86, v76, v77
    ds_write_addtid_b32 v86 offset:6800
    v_mul_f32 v64, v89, v69
    v_mul_f32 v65, v89, v68
    v_fma_f32 v89, v88, v69, v65
    v_fma_f32 v88, v88, v68, -v64
    v_mul_f32 v78, v77, v69
    v_mul_f32 v79, v77, v68
    v_fma_f32 v77, v76, v69, v79
    v_fma_f32 v76, v76, v68, -v78
    v_cvt_pk_bf16_f32 v87, v88, v89
    ds_write_addtid_b32 v87 offset:7072
    v_cvt_pk_bf16_f32 v84, v76, v77
    ds_write_addtid_b32 v84 offset:7344
    v_mul_f32 v64, v89, v69
    v_mul_f32 v65, v89, v68
    v_fma_f32 v89, v88, v69, v65
    v_fma_f32 v88, v88, v68, -v64
    v_mul_f32 v78, v77, v69
    v_mul_f32 v79, v77, v68
    v_fma_f32 v77, v76, v69, v79
    v_fma_f32 v76, v76, v68, -v78
    v_cvt_pk_bf16_f32 v85, v88, v89
    ds_write_addtid_b32 v85 offset:7616
    v_cvt_pk_bf16_f32 v86, v76, v77
    ds_write_addtid_b32 v86 offset:7888
    v_mul_f32 v64, v89, v69
    v_mul_f32 v65, v89, v68
    v_fma_f32 v89, v88, v69, v65
    v_fma_f32 v88, v88, v68, -v64
    v_mul_f32 v78, v77, v69
    v_mul_f32 v79, v77, v68
    v_fma_f32 v77, v76, v69, v79
    v_fma_f32 v76, v76, v68, -v78
    v_cvt_pk_bf16_f32 v87, v88, v89
    ds_write_addtid_b32 v87 offset:8160
    v_cvt_pk_bf16_f32 v84, v76, v77
    ds_write_addtid_b32 v84 offset:8432
    ds_read_b128 v[128:131], v10 offset:0
    ds_read_b128 v[132:135], v10 offset:32
    ds_read_b128 v[136:139], v10 offset:64
    ds_read_b128 v[140:143], v10 offset:96
    ds_read_b128 v[144:147], v10 offset:128
    ds_read_b128 v[148:151], v10 offset:160
    ds_read_b128 v[152:155], v10 offset:192
    ds_read_b128 v[156:159], v10 offset:224
    s_waitcnt lgkmcnt(7)
    v_mfma_f32_32x32x16_bf16 v[16:31], v[96:99], v[128:131], v[16:31]
    s_waitcnt lgkmcnt(6)
    v_mfma_f32_32x32x16_bf16 v[16:31], v[100:103], v[132:135], v[16:31]
    s_waitcnt lgkmcnt(5)
    v_mfma_f32_32x32x16_bf16 v[16:31], v[104:107], v[136:139], v[16:31]
    s_waitcnt lgkmcnt(4)
    v_mfma_f32_32x32x16_bf16 v[16:31], v[108:111], v[140:143], v[16:31]
    s_waitcnt lgkmcnt(3)
    v_mfma_f32_32x32x16_bf16 v[16:31], v[112:115], v[144:147], v[16:31]
    s_waitcnt lgkmcnt(2)
    v_mfma_f32_32x32x16_bf16 v[16:31], v[116:119], v[148:151], v[16:31]
    s_waitcnt lgkmcnt(1)
    v_mfma_f32_32x32x16_bf16 v[16:31], v[120:123], v[152:155], v[16:31]
    s_waitcnt lgkmcnt(0)
    v_mfma_f32_32x32x16_bf16 v[16:31], v[124:127], v[156:159], v[16:31]
    s_cmp_eq_u32 s31, 2
    s_cbranch_scc0 L_kg_nopub
    s_waitcnt vmcnt(0)
    v_readfirstlane_b32 s58, v49
    s_nop 3
    s_cmp_lg_u32 s58, 0
    s_cbranch_scc1 L_s_hasn
    v_mov_b32 v48, 0
    s_mov_b32 s59, 30000
L_nonce_s:
    global_load_dword v49, v48, s[48:49] sc1
    s_waitcnt vmcnt(0)
    v_readfirstlane_b32 s58, v49
    s_nop 3
    s_cmp_lg_u32 s58, 0
    s_cbranch_scc1 L_nonce_done_s
    s_sleep 1
    s_sub_u32 s59, s59, 1
    s_cmp_lg_u32 s59, 0
    s_cbranch_scc1 L_nonce_s
L_nonce_done_s:
L_s_hasn:
    s_lshl_b32 s28, s20, 2
    s_add_u32 s28, s28, 2304
    s_barrier
    v_mov_b32 v14, s28
    v_mov_b32 v15, s58
    v_cmp_eq_u32 vcc, 0, v0
    s_nop 3
    s_and_saveexec_b64 s[56:57], vcc
    s_cbranch_execz L_pub_s
    global_store_dword v14, v15, s[52:53] sc0 sc1
L_pub_s:
    s_mov_b64 exec, s[56:57]
    v_mov_b32 v180, 0
    v_mov_b32 v181, 0
    v_mov_b32 v182, 0
    v_mov_b32 v183, 0
    v_and_b32 v13, 31, v0
    v_lshlrev_b32 v13, 4, v13
    v_bfe_u32 v14, v0, 5, 1
    v_mul_u32_u24 v14, 4608, v14
    v_add_u32 v13, v13, v14
    v_add_u32 v13, 72192, v13
    v_cmp_gt_u32 vcc, 64, v0
    s_nop 3
    s_and_saveexec_b64 s[56:57], vcc
    s_cbranch_execz L_cv_z1
    ds_write_b128 v13, v[180:183]
L_cv_z1:
    s_mov_b64 exec, s[56:57]
    v_lshrrev_b32 v13, 1, v0
    v_mul_u32_u24 v13, 4160, v13
    v_and_b32 v14, 1, v0
    v_lshl_add_u32 v13, v14, 4, v13
    v_cmp_gt_u32 vcc, 16, v0
    s_nop 3
    s_and_saveexec_b64 s[56:57], vcc
    s_cbranch_execz L_cv_z2
    ds_write_b128 v13, v[180:183] offset:34816
L_cv_z2:
    s_mov_b64 exec, s[56:57]
L_kg_nopub:
    s_sub_u32 s31, s31, 1
    s_cmp_lg_u32 s31, 0
    s_cbranch_scc1 L_kg_round
    s_setprio 1
    s_lshl_b32 s28, s32, 7
    v_and_b32 v150, 31, v2
    v_lshlrev_b32 v150, 2, v150
    v_add_u32 v150, s28, v150
    v_add_u32 v150, 2304, v150
    s_lshl_b32 s27, s25, 12
    s_lshl_b32 s28, s20, 13
    v_lshlrev_b32 v13, 4, v0
    v_add_u32 v152, s28, v13
    v_subrev_u32 v153, 8, v13
    v_max_i32 v153, 0, v153
    v_add_u32 v153, s28, v153
    s_cmp_lg_u32 s21, 0
    s_cbranch_scc1 L_pw_done_sut
    s_mov_b32 s59, 30000
L_pw_sut:
    global_load_dword v151, v150, s[52:53] sc1
    s_waitcnt vmcnt(0)
    v_cmp_eq_u32 vcc, s58, v151
    s_nop 3
    s_cmp_eq_u64 vcc, exec
    s_cbranch_scc1 L_pw_done_sut
    s_sleep 8
    s_sub_u32 s59, s59, 1
    s_cmp_lg_u32 s59, 0
    s_cbranch_scc1 L_pw_sut
L_pw_done_sut:
    s_barrier
    global_load_dwordx2 v[160:161], v153, s[54:55] sc1
    global_load_dwordx4 v[164:167], v152, s[54:55] sc1
    v_add_u32 v154, 4096, v152
    v_add_u32 v155, 4096, v153
    global_load_dwordx2 v[168:169], v155, s[54:55] sc1
    global_load_dwordx4 v[172:175], v154, s[54:55] sc1
    v_lshlrev_b32 v11, 4, v2
    s_cmp_eq_u32 s24, 0
    s_cbranch_scc1 L_kg_skipw
    v_add_u32 v13, s30, v11
    s_nop 15
    ds_write_b128 v13, v[16:19] offset:0
    ds_write_b128 v13, v[20:23] offset:1024
    ds_write_b128 v13, v[24:27] offset:2048
L_kg_skipw:
    s_waitcnt lgkmcnt(0)
    s_barrier
    s_cmp_eq_u32 s24, 0
    s_cbranch_scc0 L_kg_notab
    s_add_u32 s28, s30, 8704
    v_add_u32 v13, s28, v11
    ds_read_b128 v[96:99], v13 offset:0
    ds_read_b128 v[100:103], v13 offset:1024
    ds_read_b128 v[104:107], v13 offset:2048
    s_mul_i32 s28, s23, 1536
    s_add_u32 s28, s28, 77312
    v_and_b32 v14, 31, v2
    v_lshlrev_b32 v14, 1, v14
    v_lshrrev_b32 v15, 5, v2
    v_lshl_add_u32 v14, v15, 8, v14
    v_add_u32 v14, s28, v14
    s_waitcnt lgkmcnt(0)
    v_add_f32 v96, v16, v96
    v_cvt_pk_bf16_f32 v96, v96, v96
    v_add_f32 v97, v17, v97
    v_cvt_pk_bf16_f32 v97, v97, v97
    v_add_f32 v98, v18, v98
    v_cvt_pk_bf16_f32 v98, v98, v98
    v_add_f32 v99, v19, v99
    v_cvt_pk_bf16_f32 v99, v99, v99
    v_add_f32 v100, v20, v100
    v_cvt_pk_bf16_f32 v100, v100, v100
    v_add_f32 v101, v21, v101
    v_cvt_pk_bf16_f32 v101, v101, v101
    v_add_f32 v102, v22, v102
    v_cvt_pk_bf16_f32 v102, v102, v102
    v_add_f32 v103, v23, v103
    v_cvt_pk_bf16_f32 v103, v103, v103
    v_add_f32 v104, v24, v104
    v_cvt_pk_bf16_f32 v104, v104, v104
    v_add_f32 v105, v25, v105
    v_cvt_pk_bf16_f32 v105, v105, v105
    v_add_f32 v106, v26, v106
    v_cvt_pk_bf16_f32 v106, v106, v106
    v_add_f32 v107, v27, v107
    v_cvt_pk_bf16_f32 v107, v107, v107
    ds_write_b16 v14, v96 offset:0
    ds_write_b16 v14, v97 offset:64
    ds_write_b16 v14, v98 offset:128
    ds_write_b16 v14, v99 offset:192
    ds_write_b16 v14, v100 offset:512
    ds_write_b16 v14, v101 offset:576
    ds_write_b16 v14, v102 offset:640
    ds_write_b16 v14, v103 offset:704
    ds_write_b16 v14, v104 offset:1024
    ds_write_b16 v14, v105 offset:1088
    ds_write_b16 v14, v106 offset:1152
    ds_write_b16 v14, v107 offset:1216
L_kg_notab:
    v_lshlrev_b32 v13, 4, v0
    v_add_u32 v13, 34848, v13
    v_cmp_eq_u32 vcc, 0, v0
    s_mul_i32 s35, s23, 16640
    s_add_u32 s35, s35, 34816
    v_mov_b32 v96, 0
    s_waitcnt vmcnt(0)
    v_cndmask_b32 v160, v160, v96, vcc
    v_cndmask_b32 v161, v161, v96, vcc
    v_alignbit_b32 v52, v161, v160, 16
    v_alignbit_b32 v53, v164, v161, 16
    v_alignbit_b32 v54, v165, v164, 16
    v_alignbit_b32 v55, v166, v165, 16
    v_alignbit_b32 v56, v164, v161, 16
    v_alignbit_b32 v57, v165, v164, 16
    v_alignbit_b32 v58, v166, v165, 16
    v_alignbit_b32 v59, v167, v166, 16
    v_mov_b32 v60, v161
    v_mov_b32 v61, v164
    v_mov_b32 v62, v165
    v_mov_b32 v63, v166
    ds_write_b128 v13, v[52:55] offset:0
    ds_write_b128 v13, v[60:63] offset:4160
    ds_write_b128 v13, v[56:59] offset:8320
    ds_write_b128 v13, v[164:167] offset:12480
    v_cndmask_b32 v168, v168, v96, vcc
    v_cndmask_b32 v169, v169, v96, vcc
    v_alignbit_b32 v64, v169, v168, 16
    v_alignbit_b32 v65, v172, v169, 16
    v_alignbit_b32 v66, v173, v172, 16
    v_alignbit_b32 v67, v174, v173, 16
    v_alignbit_b32 v68, v172, v169, 16
    v_alignbit_b32 v69, v173, v172, 16
    v_alignbit_b32 v70, v174, v173, 16
    v_alignbit_b32 v71, v175, v174, 16
    v_mov_b32 v72, v169
    v_mov_b32 v73, v172
    v_mov_b32 v74, v173
    v_mov_b32 v75, v174
    ds_write_b128 v13, v[64:67] offset:16640
    ds_write_b128 v13, v[72:75] offset:20800
    ds_write_b128 v13, v[68:71] offset:24960
    ds_write_b128 v13, v[172:175] offset:29120
    s_waitcnt lgkmcnt(0)
    s_barrier
    ds_read_u16 v100, v200 offset:0
    ds_read_u16 v101, v201 offset:0
    ds_read_u16 v102, v202 offset:0
    ds_read_u16 v103, v203 offset:0
    ds_read_u16 v104, v204 offset:0
    ds_read_u16 v105, v205 offset:0
    ds_read_u16 v106, v206 offset:0
    ds_read_u16 v107, v207 offset:0
    ds_read_u16 v108, v200 offset:1536
    ds_read_u16 v109, v201 offset:1536
    ds_read_u16 v110, v202 offset:1536
    ds_read_u16 v111, v203 offset:1536
    ds_read_u16 v112, v204 offset:1536
    ds_read_u16 v113, v205 offset:1536
    ds_read_u16 v114, v206 offset:1536
    ds_read_u16 v115, v207 offset:1536
    v_lshlrev_b32 v9, 4, v0
    v_add_u32 v9, 68096, v9
    v_and_b32 v10, 15, v2
    v_lshrrev_b32 v11, 4, v2
    v_and_b32 v12, 3, v10
    v_mul_u32_u24 v12, 4160, v12
    v_lshrrev_b32 v13, 2, v10
    v_lshl_add_u32 v12, v13, 3, v12
    v_lshl_add_u32 v12, v11, 4, v12
    s_lshl_b32 s30, s24, 8
    s_add_u32 s31, s35, s30
    s_add_u32 s31, s31, 8
    v_add_u32 v12, s31, v12
    s_mul_i32 s31, s23, 4608
    s_add_u32 s31, s31, 68576
    s_add_u32 s31, s31, s30
    v_lshlrev_b32 v13, 5, v10
    v_sub_u32 v13, s31, v13
    v_lshl_add_u32 v13, v11, 4, v13
    s_waitcnt lgkmcnt(8)
    v_lshl_or_b32 v116, v101, 16, v100
    v_lshl_or_b32 v117, v103, 16, v102
    v_lshl_or_b32 v118, v105, 16, v104
    v_lshl_or_b32 v119, v107, 16, v106
    ds_write_b128 v9, v[116:119] offset:0
    s_waitcnt lgkmcnt(1)
    v_lshl_or_b32 v120, v109, 16, v108
    v_lshl_or_b32 v121, v111, 16, v110
    v_lshl_or_b32 v122, v113, 16, v112
    v_lshl_or_b32 v123, v115, 16, v114
    ds_write_b128 v9, v[120:123] offset:4608
    v_mov_b32 v16, 0
    v_mov_b32 v17, 0
    v_mov_b32 v18, 0
    v_mov_b32 v19, 0
    v_mov_b32 v20, 0
    v_mov_b32 v21, 0
    v_mov_b32 v22, 0
    v_mov_b32 v23, 0
    v_mov_b32 v24, 0
    v_mov_b32 v25, 0
    v_mov_b32 v26, 0
    v_mov_b32 v27, 0
    v_mov_b32 v28, 0
    v_mov_b32 v29, 0
    v_mov_b32 v30, 0
    v_mov_b32 v31, 0
    v_mov_b32 v32, 0
    v_mov_b32 v33, 0
    v_mov_b32 v34, 0
    v_mov_b32 v35, 0
    v_mov_b32 v36, 0
    v_mov_b32 v37, 0
    v_mov_b32 v38, 0
    v_mov_b32 v39, 0
    v_mov_b32 v40, 0
    v_mov_b32 v41, 0
    v_mov_b32 v42, 0
    v_mov_b32 v43, 0
    v_mov_b32 v44, 0
    v_mov_b32 v45, 0
    v_mov_b32 v46, 0
    v_mov_b32 v47, 0
    s_waitcnt lgkmcnt(0)
    s_barrier
    ds_read_b64 v[64:65], v12 offset:0
    ds_read_b64 v[66:67], v12 offset:8
    ds_read_b128 v[96:99], v13 offset:3584
    ds_read_b64 v[68:69], v12 offset:512
    ds_read_b64 v[70:71], v12 offset:520
    ds_read_b128 v[100:103], v13 offset:3072
    ds_read_b64 v[72:73], v12 offset:1024
    ds_read_b64 v[74:75], v12 offset:1032
    ds_read_b128 v[104:107], v13 offset:2560
    ds_read_b64 v[76:77], v12 offset:1536
    ds_read_b64 v[78:79], v12 offset:1544
    ds_read_b128 v[108:111], v13 offset:2048
    ds_read_b64 v[80:81], v12 offset:2048
    ds_read_b64 v[82:83], v12 offset:2056
    ds_read_b128 v[112:115], v13 offset:1536
    ds_read_b64 v[84:85], v12 offset:2560
    ds_read_b64 v[86:87], v12 offset:2568
    ds_read_b128 v[116:119], v13 offset:1024
    ds_read_b64 v[88:89], v12 offset:3072
    ds_read_b64 v[90:91], v12 offset:3080
    ds_read_b128 v[120:123], v13 offset:512
    ds_read_b64 v[92:93], v12 offset:3584
    ds_read_b64 v[94:95], v12 offset:3592
    ds_read_b128 v[124:127], v13 offset:0
    s_mov_b32 s34, 2
L_cv_loop:
    s_waitcnt lgkmcnt(0)
    v_mfma_f32_16x16x32_bf16 v[16:19], v[64:67], v[96:99], v[16:19]
    ds_read_b64 v[128:129], v12 offset:64
    v_mfma_f32_16x16x32_bf16 v[20:23], v[64:67], v[100:103], v[20:23]
    ds_read_b64 v[130:131], v12 offset:72
    v_mfma_f32_16x16x32_bf16 v[24:27], v[64:67], v[104:107], v[24:27]
    ds_read_b128 v[160:163], v13 offset:3648
    v_mfma_f32_16x16x32_bf16 v[28:31], v[64:67], v[108:111], v[28:31]
    ds_read_b64 v[132:133], v12 offset:576
    v_mfma_f32_16x16x32_bf16 v[32:35], v[64:67], v[112:115], v[32:35]
    ds_read_b64 v[134:135], v12 offset:584
    v_mfma_f32_16x16x32_bf16 v[36:39], v[64:67], v[116:119], v[36:39]
    ds_read_b128 v[164:167], v13 offset:3136
    v_mfma_f32_16x16x32_bf16 v[40:43], v[64:67], v[120:123], v[40:43]
    ds_read_b64 v[136:137], v12 offset:1088
    v_mfma_f32_16x16x32_bf16 v[44:47], v[64:67], v[124:127], v[44:47]
    ds_read_b64 v[138:139], v12 offset:1096
    v_mfma_f32_16x16x32_bf16 v[20:23], v[68:71], v[96:99], v[20:23]
    ds_read_b128 v[168:171], v13 offset:2624
    v_mfma_f32_16x16x32_bf16 v[24:27], v[68:71], v[100:103], v[24:27]
    ds_read_b64 v[140:141], v12 offset:1600
    v_mfma_f32_16x16x32_bf16 v[28:31], v[68:71], v[104:107], v[28:31]
    ds_read_b64 v[142:143], v12 offset:1608
    v_mfma_f32_16x16x32_bf16 v[32:35], v[68:71], v[108:111], v[32:35]
    ds_read_b128 v[172:175], v13 offset:2112
    v_mfma_f32_16x16x32_bf16 v[36:39], v[68:71], v[112:115], v[36:39]
    ds_read_b64 v[144:145], v12 offset:2112
    v_mfma_f32_16x16x32_bf16 v[40:43], v[68:71], v[116:119], v[40:43]
    ds_read_b64 v[146:147], v12 offset:2120
    v_mfma_f32_16x16x32_bf16 v[44:47], v[68:71], v[120:123], v[44:47]
    ds_read_b128 v[176:179], v13 offset:1600
    v_mfma_f32_16x16x32_bf16 v[24:27], v[72:75], v[96:99], v[24:27]
    ds_read_b64 v[148:149], v12 offset:2624
    v_mfma_f32_16x16x32_bf16 v[28:31], v[72:75], v[100:103], v[28:31]
    ds_read_b64 v[150:151], v12 offset:2632
    v_mfma_f32_16x16x32_bf16 v[32:35], v[72:75], v[104:107], v[32:35]
    ds_read_b128 v[180:183], v13 offset:1088
    v_mfma_f32_16x16x32_bf16 v[36:39], v[72:75], v[108:111], v[36:39]
    ds_read_b64 v[152:153], v12 offset:3136
    v_mfma_f32_16x16x32_bf16 v[40:43], v[72:75], v[112:115], v[40:43]
    ds_read_b64 v[154:155], v12 offset:3144
    v_mfma_f32_16x16x32_bf16 v[44:47], v[72:75], v[116:119], v[44:47]
    ds_read_b128 v[184:187], v13 offset:576
    v_mfma_f32_16x16x32_bf16 v[28:31], v[76:79], v[96:99], v[28:31]
    ds_read_b64 v[156:157], v12 offset:3648
    v_mfma_f32_16x16x32_bf16 v[32:35], v[76:79], v[100:103], v[32:35]
    ds_read_b64 v[158:159], v12 offset:3656
    v_mfma_f32_16x16x32_bf16 v[36:39], v[76:79], v[104:107], v[36:39]
    ds_read_b128 v[188:191], v13 offset:64
    v_mfma_f32_16x16x32_bf16 v[40:43], v[76:79], v[108:111], v[40:43]
    v_mfma_f32_16x16x32_bf16 v[44:47], v[76:79], v[112:115], v[44:47]
    v_mfma_f32_16x16x32_bf16 v[32:35], v[80:83], v[96:99], v[32:35]
    v_mfma_f32_16x16x32_bf16 v[36:39], v[80:83], v[100:103], v[36:39]
    v_mfma_f32_16x16x32_bf16 v[40:43], v[80:83], v[104:107], v[40:43]
    v_mfma_f32_16x16x32_bf16 v[44:47], v[80:83], v[108:111], v[44:47]
    v_mfma_f32_16x16x32_bf16 v[36:39], v[84:87], v[96:99], v[36:39]
    v_mfma_f32_16x16x32_bf16 v[40:43], v[84:87], v[100:103], v[40:43]
    v_mfma_f32_16x16x32_bf16 v[44:47], v[84:87], v[104:107], v[44:47]
    v_mfma_f32_16x16x32_bf16 v[40:43], v[88:91], v[96:99], v[40:43]
    v_mfma_f32_16x16x32_bf16 v[44:47], v[88:91], v[100:103], v[44:47]
    v_mfma_f32_16x16x32_bf16 v[44:47], v[92:95], v[96:99], v[44:47]
    s_waitcnt lgkmcnt(0)
    v_mfma_f32_16x16x32_bf16 v[16:19], v[128:131], v[160:163], v[16:19]
    ds_read_b64 v[64:65], v12 offset:128
    v_mfma_f32_16x16x32_bf16 v[20:23], v[128:131], v[164:167], v[20:23]
    ds_read_b64 v[66:67], v12 offset:136
    v_mfma_f32_16x16x32_bf16 v[24:27], v[128:131], v[168:171], v[24:27]
    ds_read_b128 v[96:99], v13 offset:3712
    v_mfma_f32_16x16x32_bf16 v[28:31], v[128:131], v[172:175], v[28:31]
    ds_read_b64 v[68:69], v12 offset:640
    v_mfma_f32_16x16x32_bf16 v[32:35], v[128:131], v[176:179], v[32:35]
    ds_read_b64 v[70:71], v12 offset:648
    v_mfma_f32_16x16x32_bf16 v[36:39], v[128:131], v[180:183], v[36:39]
    ds_read_b128 v[100:103], v13 offset:3200
    v_mfma_f32_16x16x32_bf16 v[40:43], v[128:131], v[184:187], v[40:43]
    ds_read_b64 v[72:73], v12 offset:1152
    v_mfma_f32_16x16x32_bf16 v[44:47], v[128:131], v[188:191], v[44:47]
    ds_read_b64 v[74:75], v12 offset:1160
    v_mfma_f32_16x16x32_bf16 v[20:23], v[132:135], v[160:163], v[20:23]
    ds_read_b128 v[104:107], v13 offset:2688
    v_mfma_f32_16x16x32_bf16 v[24:27], v[132:135], v[164:167], v[24:27]
    ds_read_b64 v[76:77], v12 offset:1664
    v_mfma_f32_16x16x32_bf16 v[28:31], v[132:135], v[168:171], v[28:31]
    ds_read_b64 v[78:79], v12 offset:1672
    v_mfma_f32_16x16x32_bf16 v[32:35], v[132:135], v[172:175], v[32:35]
    ds_read_b128 v[108:111], v13 offset:2176
    v_mfma_f32_16x16x32_bf16 v[36:39], v[132:135], v[176:179], v[36:39]
    ds_read_b64 v[80:81], v12 offset:2176
    v_mfma_f32_16x16x32_bf16 v[40:43], v[132:135], v[180:183], v[40:43]
    ds_read_b64 v[82:83], v12 offset:2184
    v_mfma_f32_16x16x32_bf16 v[44:47], v[132:135], v[184:187], v[44:47]
    ds_read_b128 v[112:115], v13 offset:1664
    v_mfma_f32_16x16x32_bf16 v[24:27], v[136:139], v[160:163], v[24:27]
    ds_read_b64 v[84:85], v12 offset:2688
    v_mfma_f32_16x16x32_bf16 v[28:31], v[136:139], v[164:167], v[28:31]
    ds_read_b64 v[86:87], v12 offset:2696
    v_mfma_f32_16x16x32_bf16 v[32:35], v[136:139], v[168:171], v[32:35]
    ds_read_b128 v[116:119], v13 offset:1152
    v_mfma_f32_16x16x32_bf16 v[36:39], v[136:139], v[172:175], v[36:39]
    ds_read_b64 v[88:89], v12 offset:3200
    v_mfma_f32_16x16x32_bf16 v[40:43], v[136:139], v[176:179], v[40:43]
    ds_read_b64 v[90:91], v12 offset:3208
    v_mfma_f32_16x16x32_bf16 v[44:47], v[136:139], v[180:183], v[44:47]
    ds_read_b128 v[120:123], v13 offset:640
    v_mfma_f32_16x16x32_bf16 v[28:31], v[140:143], v[160:163], v[28:31]
    ds_read_b64 v[92:93], v12 offset:3712
    v_mfma_f32_16x16x32_bf16 v[32:35], v[140:143], v[164:167], v[32:35]
    ds_read_b64 v[94:95], v12 offset:3720
    v_mfma_f32_16x16x32_bf16 v[36:39], v[140:143], v[168:171], v[36:39]
    ds_read_b128 v[124:127], v13 offset:128
    v_mfma_f32_16x16x32_bf16 v[40:43], v[140:143], v[172:175], v[40:43]
    v_mfma_f32_16x16x32_bf16 v[44:47], v[140:143], v[176:179], v[44:47]
    v_mfma_f32_16x16x32_bf16 v[32:35], v[144:147], v[160:163], v[32:35]
    v_mfma_f32_16x16x32_bf16 v[36:39], v[144:147], v[164:167], v[36:39]
    v_mfma_f32_16x16x32_bf16 v[40:43], v[144:147], v[168:171], v[40:43]
    v_mfma_f32_16x16x32_bf16 v[44:47], v[144:147], v[172:175], v[44:47]
    v_mfma_f32_16x16x32_bf16 v[36:39], v[148:151], v[160:163], v[36:39]
    v_mfma_f32_16x16x32_bf16 v[40:43], v[148:151], v[164:167], v[40:43]
    v_mfma_f32_16x16x32_bf16 v[44:47], v[148:151], v[168:171], v[44:47]
    v_mfma_f32_16x16x32_bf16 v[40:43], v[152:155], v[160:163], v[40:43]
    v_mfma_f32_16x16x32_bf16 v[44:47], v[152:155], v[164:167], v[44:47]
    v_mfma_f32_16x16x32_bf16 v[44:47], v[156:159], v[160:163], v[44:47]
    v_add_u32 v12, 128, v12
    v_add_u32 v13, 128, v13
    s_sub_u32 s34, s34, 1
    s_cmp_lg_u32 s34, 0
    s_cbranch_scc1 L_cv_loop
    s_waitcnt lgkmcnt(0)
    v_lshlrev_b32 v14, 4, v2
    s_lshl_b32 s31, s21, 12
    s_add_u32 s31, s31, 0
    v_add_u32 v15, s31, v14
    s_xor_b32 s32, s21, 1
    s_lshl_b32 s32, s32, 12
    s_add_u32 s32, s32, 0
    v_add_u32 v14, s32, v14
    s_cmp_eq_u32 s24, 0
    s_cbranch_scc1 L_cv_x0
    ds_write_b128 v15, v[16:19] offset:0
    ds_write_b128 v15, v[20:23] offset:1024
    ds_write_b128 v15, v[24:27] offset:2048
    ds_write_b128 v15, v[28:31] offset:3072
    v_mov_b32 v16, v32
    v_mov_b32 v17, v33
    v_mov_b32 v18, v34
    v_mov_b32 v19, v35
    v_mov_b32 v20, v36
    v_mov_b32 v21, v37
    v_mov_b32 v22, v38
    v_mov_b32 v23, v39
    v_mov_b32 v24, v40
    v_mov_b32 v25, v41
    v_mov_b32 v26, v42
    v_mov_b32 v27, v43
    v_mov_b32 v28, v44
    v_mov_b32 v29, v45
    v_mov_b32 v30, v46
    v_mov_b32 v31, v47
    s_branch L_cv_x1
L_cv_x0:
    ds_write_b128 v15, v[32:35] offset:0
    ds_write_b128 v15, v[36:39] offset:1024
    ds_write_b128 v15, v[40:43] offset:2048
    ds_write_b128 v15, v[44:47] offset:3072
L_cv_x1:
    v_lshlrev_b32 v9, 5, v10
    v_lshl_add_u32 v9, v11, 3, v9
    s_lshl_b32 s31, s24, 11
    v_add_u32 v9, s31, v9
    s_add_u32 s32, s35, 12512
    v_add_u32 v8, s32, v9
    s_add_u32 s10, s50, 12582912
    s_addc_u32 s11, s51, 0
    v_add_u32 v9, s27, v9
    s_waitcnt lgkmcnt(0)
    s_barrier
    ds_read_b128 v[64:67], v14 offset:0
    ds_read_b128 v[68:71], v14 offset:1024
    ds_read_b128 v[72:75], v14 offset:2048
    ds_read_b128 v[76:79], v14 offset:3072
    ds_read_b64 v[96:97], v8 offset:0
    ds_read_b64 v[98:99], v8 offset:512
    ds_read_b64 v[100:101], v8 offset:1024
    ds_read_b64 v[102:103], v8 offset:1536
    s_waitcnt lgkmcnt(0)
    v_lshlrev_b32 v112, 16, v96
    v_add_f32 v16, v16, v64
    v_mul_f32 v112, s29, v112
    v_cvt_pk_bf16_f32 v16, 0, v16
    v_cvt_pk_bf16_f32 v112, 0, v112
    v_add_f32 v16, v16, v112
    v_and_b32 v113, 0xffff0000, v96
    v_add_f32 v17, v17, v65
    v_mul_f32 v113, s29, v113
    v_cvt_pk_bf16_f32 v17, 0, v17
    v_cvt_pk_bf16_f32 v113, 0, v113
    v_add_f32 v17, v17, v113
    v_lshlrev_b32 v114, 16, v97
    v_add_f32 v18, v18, v66
    v_mul_f32 v114, s29, v114
    v_cvt_pk_bf16_f32 v18, 0, v18
    v_cvt_pk_bf16_f32 v114, 0, v114
    v_add_f32 v18, v18, v114
    v_and_b32 v115, 0xffff0000, v97
    v_add_f32 v19, v19, v67
    v_mul_f32 v115, s29, v115
    v_cvt_pk_bf16_f32 v19, 0, v19
    v_cvt_pk_bf16_f32 v115, 0, v115
    v_add_f32 v19, v19, v115
    v_cvt_pk_bf16_f32 v104, v16, v17
    v_cvt_pk_bf16_f32 v105, v18, v19
    global_store_dwordx2 v9, v[104:105], s[10:11] offset:0 sc1
    v_lshlrev_b32 v116, 16, v98
    v_add_f32 v20, v20, v68
    v_mul_f32 v116, s29, v116
    v_cvt_pk_bf16_f32 v20, 0, v20
    v_cvt_pk_bf16_f32 v116, 0, v116
    v_add_f32 v20, v20, v116
    v_and_b32 v117, 0xffff0000, v98
    v_add_f32 v21, v21, v69
    v_mul_f32 v117, s29, v117
    v_cvt_pk_bf16_f32 v21, 0, v21
    v_cvt_pk_bf16_f32 v117, 0, v117
    v_add_f32 v21, v21, v117
    v_lshlrev_b32 v118, 16, v99
    v_add_f32 v22, v22, v70
    v_mul_f32 v118, s29, v118
    v_cvt_pk_bf16_f32 v22, 0, v22
    v_cvt_pk_bf16_f32 v118, 0, v118
    v_add_f32 v22, v22, v118
    v_and_b32 v119, 0xffff0000, v99
    v_add_f32 v23, v23, v71
    v_mul_f32 v119, s29, v119
    v_cvt_pk_bf16_f32 v23, 0, v23
    v_cvt_pk_bf16_f32 v119, 0, v119
    v_add_f32 v23, v23, v119
    v_cvt_pk_bf16_f32 v106, v20, v21
    v_cvt_pk_bf16_f32 v107, v22, v23
    global_store_dwordx2 v9, v[106:107], s[10:11] offset:512 sc1
    v_lshlrev_b32 v120, 16, v100
    v_add_f32 v24, v24, v72
    v_mul_f32 v120, s29, v120
    v_cvt_pk_bf16_f32 v24, 0, v24
    v_cvt_pk_bf16_f32 v120, 0, v120
    v_add_f32 v24, v24, v120
    v_and_b32 v121, 0xffff0000, v100
    v_add_f32 v25, v25, v73
    v_mul_f32 v121, s29, v121
    v_cvt_pk_bf16_f32 v25, 0, v25
    v_cvt_pk_bf16_f32 v121, 0, v121
    v_add_f32 v25, v25, v121
    v_lshlrev_b32 v122, 16, v101
    v_add_f32 v26, v26, v74
    v_mul_f32 v122, s29, v122
    v_cvt_pk_bf16_f32 v26, 0, v26
    v_cvt_pk_bf16_f32 v122, 0, v122
    v_add_f32 v26, v26, v122
    v_and_b32 v123, 0xffff0000, v101
    v_add_f32 v27, v27, v75
    v_mul_f32 v123, s29, v123
    v_cvt_pk_bf16_f32 v27, 0, v27
    v_cvt_pk_bf16_f32 v123, 0, v123
    v_add_f32 v27, v27, v123
    v_cvt_pk_bf16_f32 v108, v24, v25
    v_cvt_pk_bf16_f32 v109, v26, v27
    global_store_dwordx2 v9, v[108:109], s[10:11] offset:1024 sc1
    v_lshlrev_b32 v124, 16, v102
    v_add_f32 v28, v28, v76
    v_mul_f32 v124, s29, v124
    v_cvt_pk_bf16_f32 v28, 0, v28
    v_cvt_pk_bf16_f32 v124, 0, v124
    v_add_f32 v28, v28, v124
    v_and_b32 v125, 0xffff0000, v102
    v_add_f32 v29, v29, v77
    v_mul_f32 v125, s29, v125
    v_cvt_pk_bf16_f32 v29, 0, v29
    v_cvt_pk_bf16_f32 v125, 0, v125
    v_add_f32 v29, v29, v125
    v_lshlrev_b32 v126, 16, v103
    v_add_f32 v30, v30, v78
    v_mul_f32 v126, s29, v126
    v_cvt_pk_bf16_f32 v30, 0, v30
    v_cvt_pk_bf16_f32 v126, 0, v126
    v_add_f32 v30, v30, v126
    v_and_b32 v127, 0xffff0000, v103
    v_add_f32 v31, v31, v79
    v_mul_f32 v127, s29, v127
    v_cvt_pk_bf16_f32 v31, 0, v31
    v_cvt_pk_bf16_f32 v127, 0, v127
    v_add_f32 v31, v31, v127
    v_cvt_pk_bf16_f32 v110, v28, v29
    v_cvt_pk_bf16_f32 v111, v30, v31
    global_store_dwordx2 v9, v[110:111], s[10:11] offset:1536 sc1
    s_waitcnt vmcnt(0)
    s_lshl_b32 s28, s20, 2
    s_add_u32 s28, s28, 3328
    s_barrier
    v_mov_b32 v14, s28
    v_mov_b32 v15, s58
    v_cmp_eq_u32 vcc, 0, v0
    s_nop 3
    s_and_saveexec_b64 s[56:57], vcc
    s_cbranch_execz L_pub_at
    global_store_dword v14, v15, s[52:53] sc0 sc1
L_pub_at:
    s_mov_b64 exec, s[56:57]
    s_endpgm
L_gate:
    s_getpc_b64 s[62:63]
L_pc_here_gate:
    s_sub_u32 s62, s62, L_pc_here_gate-gated_mix__ssm_conv_s4__glu_gated_bilinear__prompt_kernel
    s_subb_u32 s63, s63, 0
    v_lshlrev_b32 v250, 7, v0
    v_min_u32 v250, L_code_end-gated_mix__ssm_conv_s4__glu_gated_bilinear__prompt_kernel-4, v250
    global_load_dword v251, v250, s[62:63]
    s_sub_u32 s20, s2, 224
    s_load_dwordx2 s[4:5], s[0:1], 0
    s_load_dwordx2 s[8:9], s[0:1], 104
    s_load_dwordx4 s[48:51], s[0:1], 120
    v_lshrrev_b32 v1, 6, v0
    v_and_b32 v2, 63, v0
    v_readfirstlane_b32 s21, v1
    v_and_b32 v4, 7, v2
    v_lshlrev_b32 v4, 4, v4
    v_lshrrev_b32 v5, 3, v2
    s_lshl_b32 s22, s20, 6
    s_lshl_b32 s23, s21, 4
    s_add_u32 s22, s22, s23
    v_add_u32 v5, s22, v5
    v_mul_u32_u24 v3, 896, v5
    v_add_u32 v3, v3, v4
    v_lshlrev_b32 v5, 2, v5
    s_waitcnt lgkmcnt(0)
    s_mov_b32 s6, 1835008
    s_mov_b32 s7, 0x20000
    s_mov_b32 s10, 896
    s_mov_b32 s11, 0x20000
    buffer_load_dwordx4 v[64:67], v4, s[8:11], 0 offen offset:0
    buffer_load_dwordx4 v[68:71], v4, s[8:11], 0 offen offset:128
    buffer_load_dwordx4 v[72:75], v4, s[8:11], 0 offen offset:256
    buffer_load_dwordx4 v[76:79], v4, s[8:11], 0 offen offset:384
    buffer_load_dwordx4 v[80:83], v4, s[8:11], 0 offen offset:512
    buffer_load_dwordx4 v[84:87], v4, s[8:11], 0 offen offset:640
    buffer_load_dwordx4 v[88:91], v4, s[8:11], 0 offen offset:768
    buffer_load_dwordx4 v[96:99], v3, s[4:7], 0 offen offset:0
    buffer_load_dwordx4 v[100:103], v3, s[4:7], 0 offen offset:128
    buffer_load_dwordx4 v[104:107], v3, s[4:7], 0 offen offset:256
    buffer_load_dwordx4 v[108:111], v3, s[4:7], 0 offen offset:384
    buffer_load_dwordx4 v[112:115], v3, s[4:7], 0 offen offset:512
    buffer_load_dwordx4 v[116:119], v3, s[4:7], 0 offen offset:640
    buffer_load_dwordx4 v[120:123], v3, s[4:7], 0 offen offset:768
    v_add_u32 v3, 7168, v3
    buffer_load_dwordx4 v[128:131], v3, s[4:7], 0 offen offset:0
    buffer_load_dwordx4 v[132:135], v3, s[4:7], 0 offen offset:128
    buffer_load_dwordx4 v[136:139], v3, s[4:7], 0 offen offset:256
    buffer_load_dwordx4 v[140:143], v3, s[4:7], 0 offen offset:384
    buffer_load_dwordx4 v[144:147], v3, s[4:7], 0 offen offset:512
    buffer_load_dwordx4 v[148:151], v3, s[4:7], 0 offen offset:640
    buffer_load_dwordx4 v[152:155], v3, s[4:7], 0 offen offset:768
    v_mov_b32 v14, 0
    global_load_dword v15, v14, s[48:49] sc1
    v_mov_b32 v9, 0x3f803f80
    s_add_u32 s14, s50, 10027008
    s_addc_u32 s15, s51, 0
    s_add_u32 s52, s50, 10092544
    s_addc_u32 s53, s51, 0
    s_waitcnt vmcnt(0)
    v_mov_b32 v8, 0
    v_lshlrev_b32 v10, 16, v96
    v_and_b32 v11, 0xffff0000, v96
    v_lshlrev_b32 v12, 16, v64
    v_and_b32 v13, 0xffff0000, v64
    v_pk_mul_f32 v[10:11], v[10:11], v[12:13]
    v_cvt_pk_bf16_f32 v10, v10, v11
    v_dot2c_f32_bf16 v8, v10, v9
    v_lshlrev_b32 v10, 16, v97
    v_and_b32 v11, 0xffff0000, v97
    v_lshlrev_b32 v12, 16, v65
    v_and_b32 v13, 0xffff0000, v65
    v_pk_mul_f32 v[10:11], v[10:11], v[12:13]
    v_cvt_pk_bf16_f32 v10, v10, v11
    v_dot2c_f32_bf16 v8, v10, v9
    v_lshlrev_b32 v10, 16, v98
    v_and_b32 v11, 0xffff0000, v98
    v_lshlrev_b32 v12, 16, v66
    v_and_b32 v13, 0xffff0000, v66
    v_pk_mul_f32 v[10:11], v[10:11], v[12:13]
    v_cvt_pk_bf16_f32 v10, v10, v11
    v_dot2c_f32_bf16 v8, v10, v9
    v_lshlrev_b32 v10, 16, v99
    v_and_b32 v11, 0xffff0000, v99
    v_lshlrev_b32 v12, 16, v67
    v_and_b32 v13, 0xffff0000, v67
    v_pk_mul_f32 v[10:11], v[10:11], v[12:13]
    v_cvt_pk_bf16_f32 v10, v10, v11
    v_dot2c_f32_bf16 v8, v10, v9
    v_lshlrev_b32 v10, 16, v100
    v_and_b32 v11, 0xffff0000, v100
    v_lshlrev_b32 v12, 16, v68
    v_and_b32 v13, 0xffff0000, v68
    v_pk_mul_f32 v[10:11], v[10:11], v[12:13]
    v_cvt_pk_bf16_f32 v10, v10, v11
    v_dot2c_f32_bf16 v8, v10, v9
    v_lshlrev_b32 v10, 16, v101
    v_and_b32 v11, 0xffff0000, v101
    v_lshlrev_b32 v12, 16, v69
    v_and_b32 v13, 0xffff0000, v69
    v_pk_mul_f32 v[10:11], v[10:11], v[12:13]
    v_cvt_pk_bf16_f32 v10, v10, v11
    v_dot2c_f32_bf16 v8, v10, v9
    v_lshlrev_b32 v10, 16, v102
    v_and_b32 v11, 0xffff0000, v102
    v_lshlrev_b32 v12, 16, v70
    v_and_b32 v13, 0xffff0000, v70
    v_pk_mul_f32 v[10:11], v[10:11], v[12:13]
    v_cvt_pk_bf16_f32 v10, v10, v11
    v_dot2c_f32_bf16 v8, v10, v9
    v_lshlrev_b32 v10, 16, v103
    v_and_b32 v11, 0xffff0000, v103
    v_lshlrev_b32 v12, 16, v71
    v_and_b32 v13, 0xffff0000, v71
    v_pk_mul_f32 v[10:11], v[10:11], v[12:13]
    v_cvt_pk_bf16_f32 v10, v10, v11
    v_dot2c_f32_bf16 v8, v10, v9
    v_lshlrev_b32 v10, 16, v104
    v_and_b32 v11, 0xffff0000, v104
    v_lshlrev_b32 v12, 16, v72
    v_and_b32 v13, 0xffff0000, v72
    v_pk_mul_f32 v[10:11], v[10:11], v[12:13]
    v_cvt_pk_bf16_f32 v10, v10, v11
    v_dot2c_f32_bf16 v8, v10, v9
    v_lshlrev_b32 v10, 16, v105
    v_and_b32 v11, 0xffff0000, v105
    v_lshlrev_b32 v12, 16, v73
    v_and_b32 v13, 0xffff0000, v73
    v_pk_mul_f32 v[10:11], v[10:11], v[12:13]
    v_cvt_pk_bf16_f32 v10, v10, v11
    v_dot2c_f32_bf16 v8, v10, v9
    v_lshlrev_b32 v10, 16, v106
    v_and_b32 v11, 0xffff0000, v106
    v_lshlrev_b32 v12, 16, v74
    v_and_b32 v13, 0xffff0000, v74
    v_pk_mul_f32 v[10:11], v[10:11], v[12:13]
    v_cvt_pk_bf16_f32 v10, v10, v11
    v_dot2c_f32_bf16 v8, v10, v9
    v_lshlrev_b32 v10, 16, v107
    v_and_b32 v11, 0xffff0000, v107
    v_lshlrev_b32 v12, 16, v75
    v_and_b32 v13, 0xffff0000, v75
    v_pk_mul_f32 v[10:11], v[10:11], v[12:13]
    v_cvt_pk_bf16_f32 v10, v10, v11
    v_dot2c_f32_bf16 v8, v10, v9
    v_lshlrev_b32 v10, 16, v108
    v_and_b32 v11, 0xffff0000, v108
    v_lshlrev_b32 v12, 16, v76
    v_and_b32 v13, 0xffff0000, v76
    v_pk_mul_f32 v[10:11], v[10:11], v[12:13]
    v_cvt_pk_bf16_f32 v10, v10, v11
    v_dot2c_f32_bf16 v8, v10, v9
    v_lshlrev_b32 v10, 16, v109
    v_and_b32 v11, 0xffff0000, v109
    v_lshlrev_b32 v12, 16, v77
    v_and_b32 v13, 0xffff0000, v77
    v_pk_mul_f32 v[10:11], v[10:11], v[12:13]
    v_cvt_pk_bf16_f32 v10, v10, v11
    v_dot2c_f32_bf16 v8, v10, v9
    v_lshlrev_b32 v10, 16, v110
    v_and_b32 v11, 0xffff0000, v110
    v_lshlrev_b32 v12, 16, v78
    v_and_b32 v13, 0xffff0000, v78
    v_pk_mul_f32 v[10:11], v[10:11], v[12:13]
    v_cvt_pk_bf16_f32 v10, v10, v11
    v_dot2c_f32_bf16 v8, v10, v9
    v_lshlrev_b32 v10, 16, v111
    v_and_b32 v11, 0xffff0000, v111
    v_lshlrev_b32 v12, 16, v79
    v_and_b32 v13, 0xffff0000, v79
    v_pk_mul_f32 v[10:11], v[10:11], v[12:13]
    v_cvt_pk_bf16_f32 v10, v10, v11
    v_dot2c_f32_bf16 v8, v10, v9
    v_lshlrev_b32 v10, 16, v112
    v_and_b32 v11, 0xffff0000, v112
    v_lshlrev_b32 v12, 16, v80
    v_and_b32 v13, 0xffff0000, v80
    v_pk_mul_f32 v[10:11], v[10:11], v[12:13]
    v_cvt_pk_bf16_f32 v10, v10, v11
    v_dot2c_f32_bf16 v8, v10, v9
    v_lshlrev_b32 v10, 16, v113
    v_and_b32 v11, 0xffff0000, v113
    v_lshlrev_b32 v12, 16, v81
    v_and_b32 v13, 0xffff0000, v81
    v_pk_mul_f32 v[10:11], v[10:11], v[12:13]
    v_cvt_pk_bf16_f32 v10, v10, v11
    v_dot2c_f32_bf16 v8, v10, v9
    v_lshlrev_b32 v10, 16, v114
    v_and_b32 v11, 0xffff0000, v114
    v_lshlrev_b32 v12, 16, v82
    v_and_b32 v13, 0xffff0000, v82
    v_pk_mul_f32 v[10:11], v[10:11], v[12:13]
    v_cvt_pk_bf16_f32 v10, v10, v11
    v_dot2c_f32_bf16 v8, v10, v9
    v_lshlrev_b32 v10, 16, v115
    v_and_b32 v11, 0xffff0000, v115
    v_lshlrev_b32 v12, 16, v83
    v_and_b32 v13, 0xffff0000, v83
    v_pk_mul_f32 v[10:11], v[10:11], v[12:13]
    v_cvt_pk_bf16_f32 v10, v10, v11
    v_dot2c_f32_bf16 v8, v10, v9
    v_lshlrev_b32 v10, 16, v116
    v_and_b32 v11, 0xffff0000, v116
    v_lshlrev_b32 v12, 16, v84
    v_and_b32 v13, 0xffff0000, v84
    v_pk_mul_f32 v[10:11], v[10:11], v[12:13]
    v_cvt_pk_bf16_f32 v10, v10, v11
    v_dot2c_f32_bf16 v8, v10, v9
    v_lshlrev_b32 v10, 16, v117
    v_and_b32 v11, 0xffff0000, v117
    v_lshlrev_b32 v12, 16, v85
    v_and_b32 v13, 0xffff0000, v85
    v_pk_mul_f32 v[10:11], v[10:11], v[12:13]
    v_cvt_pk_bf16_f32 v10, v10, v11
    v_dot2c_f32_bf16 v8, v10, v9
    v_lshlrev_b32 v10, 16, v118
    v_and_b32 v11, 0xffff0000, v118
    v_lshlrev_b32 v12, 16, v86
    v_and_b32 v13, 0xffff0000, v86
    v_pk_mul_f32 v[10:11], v[10:11], v[12:13]
    v_cvt_pk_bf16_f32 v10, v10, v11
    v_dot2c_f32_bf16 v8, v10, v9
    v_lshlrev_b32 v10, 16, v119
    v_and_b32 v11, 0xffff0000, v119
    v_lshlrev_b32 v12, 16, v87
    v_and_b32 v13, 0xffff0000, v87
    v_pk_mul_f32 v[10:11], v[10:11], v[12:13]
    v_cvt_pk_bf16_f32 v10, v10, v11
    v_dot2c_f32_bf16 v8, v10, v9
    v_lshlrev_b32 v10, 16, v120
    v_and_b32 v11, 0xffff0000, v120
    v_lshlrev_b32 v12, 16, v88
    v_and_b32 v13, 0xffff0000, v88
    v_pk_mul_f32 v[10:11], v[10:11], v[12:13]
    v_cvt_pk_bf16_f32 v10, v10, v11
    v_dot2c_f32_bf16 v8, v10, v9
    v_lshlrev_b32 v10, 16, v121
    v_and_b32 v11, 0xffff0000, v121
    v_lshlrev_b32 v12, 16, v89
    v_and_b32 v13, 0xffff0000, v89
    v_pk_mul_f32 v[10:11], v[10:11], v[12:13]
    v_cvt_pk_bf16_f32 v10, v10, v11
    v_dot2c_f32_bf16 v8, v10, v9
    v_lshlrev_b32 v10, 16, v122
    v_and_b32 v11, 0xffff0000, v122
    v_lshlrev_b32 v12, 16, v90
    v_and_b32 v13, 0xffff0000, v90
    v_pk_mul_f32 v[10:11], v[10:11], v[12:13]
    v_cvt_pk_bf16_f32 v10, v10, v11
    v_dot2c_f32_bf16 v8, v10, v9
    v_lshlrev_b32 v10, 16, v123
    v_and_b32 v11, 0xffff0000, v123
    v_lshlrev_b32 v12, 16, v91
    v_and_b32 v13, 0xffff0000, v91
    v_pk_mul_f32 v[10:11], v[10:11], v[12:13]
    v_cvt_pk_bf16_f32 v10, v10, v11
    v_dot2c_f32_bf16 v8, v10, v9
    s_nop 3
    v_add_f32_dpp v8, v8, v8 quad_perm:[1,0,3,2] row_mask:0xf bank_mask:0xf
    s_nop 1
    v_add_f32_dpp v8, v8, v8 quad_perm:[2,3,0,1] row_mask:0xf bank_mask:0xf
    s_nop 1
    v_add_f32_dpp v8, v8, v8 row_half_mirror row_mask:0xf bank_mask:0xf
    v_cvt_pk_bf16_f32 v8, 0, v8
    v_mul_f32 v8, 0xbfb8aa3b, v8
    v_exp_f32 v8, v8
    s_nop 0
    v_add_f32 v8, 1.0, v8
    v_rcp_f32 v8, v8
    s_nop 0
    v_cvt_pk_bf16_f32 v8, 0, v8
    v_and_b32 v11, 7, v2
    v_cmp_eq_u32 vcc, 0, v11
    s_nop 3
    s_and_saveexec_b64 s[28:29], vcc
    global_store_dword v5, v8, s[14:15] sc1
    s_mov_b64 exec, s[28:29]
    v_add_u32 v5, 32, v5
    v_mov_b32 v8, 0
    v_lshlrev_b32 v10, 16, v128
    v_and_b32 v11, 0xffff0000, v128
    v_lshlrev_b32 v12, 16, v64
    v_and_b32 v13, 0xffff0000, v64
    v_pk_mul_f32 v[10:11], v[10:11], v[12:13]
    v_cvt_pk_bf16_f32 v10, v10, v11
    v_dot2c_f32_bf16 v8, v10, v9
    v_lshlrev_b32 v10, 16, v129
    v_and_b32 v11, 0xffff0000, v129
    v_lshlrev_b32 v12, 16, v65
    v_and_b32 v13, 0xffff0000, v65
    v_pk_mul_f32 v[10:11], v[10:11], v[12:13]
    v_cvt_pk_bf16_f32 v10, v10, v11
    v_dot2c_f32_bf16 v8, v10, v9
    v_lshlrev_b32 v10, 16, v130
    v_and_b32 v11, 0xffff0000, v130
    v_lshlrev_b32 v12, 16, v66
    v_and_b32 v13, 0xffff0000, v66
    v_pk_mul_f32 v[10:11], v[10:11], v[12:13]
    v_cvt_pk_bf16_f32 v10, v10, v11
    v_dot2c_f32_bf16 v8, v10, v9
    v_lshlrev_b32 v10, 16, v131
    v_and_b32 v11, 0xffff0000, v131
    v_lshlrev_b32 v12, 16, v67
    v_and_b32 v13, 0xffff0000, v67
    v_pk_mul_f32 v[10:11], v[10:11], v[12:13]
    v_cvt_pk_bf16_f32 v10, v10, v11
    v_dot2c_f32_bf16 v8, v10, v9
    v_lshlrev_b32 v10, 16, v132
    v_and_b32 v11, 0xffff0000, v132
    v_lshlrev_b32 v12, 16, v68
    v_and_b32 v13, 0xffff0000, v68
    v_pk_mul_f32 v[10:11], v[10:11], v[12:13]
    v_cvt_pk_bf16_f32 v10, v10, v11
    v_dot2c_f32_bf16 v8, v10, v9
    v_lshlrev_b32 v10, 16, v133
    v_and_b32 v11, 0xffff0000, v133
    v_lshlrev_b32 v12, 16, v69
    v_and_b32 v13, 0xffff0000, v69
    v_pk_mul_f32 v[10:11], v[10:11], v[12:13]
    v_cvt_pk_bf16_f32 v10, v10, v11
    v_dot2c_f32_bf16 v8, v10, v9
    v_lshlrev_b32 v10, 16, v134
    v_and_b32 v11, 0xffff0000, v134
    v_lshlrev_b32 v12, 16, v70
    v_and_b32 v13, 0xffff0000, v70
    v_pk_mul_f32 v[10:11], v[10:11], v[12:13]
    v_cvt_pk_bf16_f32 v10, v10, v11
    v_dot2c_f32_bf16 v8, v10, v9
    v_lshlrev_b32 v10, 16, v135
    v_and_b32 v11, 0xffff0000, v135
    v_lshlrev_b32 v12, 16, v71
    v_and_b32 v13, 0xffff0000, v71
    v_pk_mul_f32 v[10:11], v[10:11], v[12:13]
    v_cvt_pk_bf16_f32 v10, v10, v11
    v_dot2c_f32_bf16 v8, v10, v9
    v_lshlrev_b32 v10, 16, v136
    v_and_b32 v11, 0xffff0000, v136
    v_lshlrev_b32 v12, 16, v72
    v_and_b32 v13, 0xffff0000, v72
    v_pk_mul_f32 v[10:11], v[10:11], v[12:13]
    v_cvt_pk_bf16_f32 v10, v10, v11
    v_dot2c_f32_bf16 v8, v10, v9
    v_lshlrev_b32 v10, 16, v137
    v_and_b32 v11, 0xffff0000, v137
    v_lshlrev_b32 v12, 16, v73
    v_and_b32 v13, 0xffff0000, v73
    v_pk_mul_f32 v[10:11], v[10:11], v[12:13]
    v_cvt_pk_bf16_f32 v10, v10, v11
    v_dot2c_f32_bf16 v8, v10, v9
    v_lshlrev_b32 v10, 16, v138
    v_and_b32 v11, 0xffff0000, v138
    v_lshlrev_b32 v12, 16, v74
    v_and_b32 v13, 0xffff0000, v74
    v_pk_mul_f32 v[10:11], v[10:11], v[12:13]
    v_cvt_pk_bf16_f32 v10, v10, v11
    v_dot2c_f32_bf16 v8, v10, v9
    v_lshlrev_b32 v10, 16, v139
    v_and_b32 v11, 0xffff0000, v139
    v_lshlrev_b32 v12, 16, v75
    v_and_b32 v13, 0xffff0000, v75
    v_pk_mul_f32 v[10:11], v[10:11], v[12:13]
    v_cvt_pk_bf16_f32 v10, v10, v11
    v_dot2c_f32_bf16 v8, v10, v9
    v_lshlrev_b32 v10, 16, v140
    v_and_b32 v11, 0xffff0000, v140
    v_lshlrev_b32 v12, 16, v76
    v_and_b32 v13, 0xffff0000, v76
    v_pk_mul_f32 v[10:11], v[10:11], v[12:13]
    v_cvt_pk_bf16_f32 v10, v10, v11
    v_dot2c_f32_bf16 v8, v10, v9
    v_lshlrev_b32 v10, 16, v141
    v_and_b32 v11, 0xffff0000, v141
    v_lshlrev_b32 v12, 16, v77
    v_and_b32 v13, 0xffff0000, v77
    v_pk_mul_f32 v[10:11], v[10:11], v[12:13]
    v_cvt_pk_bf16_f32 v10, v10, v11
    v_dot2c_f32_bf16 v8, v10, v9
    v_lshlrev_b32 v10, 16, v142
    v_and_b32 v11, 0xffff0000, v142
    v_lshlrev_b32 v12, 16, v78
    v_and_b32 v13, 0xffff0000, v78
    v_pk_mul_f32 v[10:11], v[10:11], v[12:13]
    v_cvt_pk_bf16_f32 v10, v10, v11
    v_dot2c_f32_bf16 v8, v10, v9
    v_lshlrev_b32 v10, 16, v143
    v_and_b32 v11, 0xffff0000, v143
    v_lshlrev_b32 v12, 16, v79
    v_and_b32 v13, 0xffff0000, v79
    v_pk_mul_f32 v[10:11], v[10:11], v[12:13]
    v_cvt_pk_bf16_f32 v10, v10, v11
    v_dot2c_f32_bf16 v8, v10, v9
    v_lshlrev_b32 v10, 16, v144
    v_and_b32 v11, 0xffff0000, v144
    v_lshlrev_b32 v12, 16, v80
    v_and_b32 v13, 0xffff0000, v80
    v_pk_mul_f32 v[10:11], v[10:11], v[12:13]
    v_cvt_pk_bf16_f32 v10, v10, v11
    v_dot2c_f32_bf16 v8, v10, v9
    v_lshlrev_b32 v10, 16, v145
    v_and_b32 v11, 0xffff0000, v145
    v_lshlrev_b32 v12, 16, v81
    v_and_b32 v13, 0xffff0000, v81
    v_pk_mul_f32 v[10:11], v[10:11], v[12:13]
    v_cvt_pk_bf16_f32 v10, v10, v11
    v_dot2c_f32_bf16 v8, v10, v9
    v_lshlrev_b32 v10, 16, v146
    v_and_b32 v11, 0xffff0000, v146
    v_lshlrev_b32 v12, 16, v82
    v_and_b32 v13, 0xffff0000, v82
    v_pk_mul_f32 v[10:11], v[10:11], v[12:13]
    v_cvt_pk_bf16_f32 v10, v10, v11
    v_dot2c_f32_bf16 v8, v10, v9
    v_lshlrev_b32 v10, 16, v147
    v_and_b32 v11, 0xffff0000, v147
    v_lshlrev_b32 v12, 16, v83
    v_and_b32 v13, 0xffff0000, v83
    v_pk_mul_f32 v[10:11], v[10:11], v[12:13]
    v_cvt_pk_bf16_f32 v10, v10, v11
    v_dot2c_f32_bf16 v8, v10, v9
    v_lshlrev_b32 v10, 16, v148
    v_and_b32 v11, 0xffff0000, v148
    v_lshlrev_b32 v12, 16, v84
    v_and_b32 v13, 0xffff0000, v84
    v_pk_mul_f32 v[10:11], v[10:11], v[12:13]
    v_cvt_pk_bf16_f32 v10, v10, v11
    v_dot2c_f32_bf16 v8, v10, v9
    v_lshlrev_b32 v10, 16, v149
    v_and_b32 v11, 0xffff0000, v149
    v_lshlrev_b32 v12, 16, v85
    v_and_b32 v13, 0xffff0000, v85
    v_pk_mul_f32 v[10:11], v[10:11], v[12:13]
    v_cvt_pk_bf16_f32 v10, v10, v11
    v_dot2c_f32_bf16 v8, v10, v9
    v_lshlrev_b32 v10, 16, v150
    v_and_b32 v11, 0xffff0000, v150
    v_lshlrev_b32 v12, 16, v86
    v_and_b32 v13, 0xffff0000, v86
    v_pk_mul_f32 v[10:11], v[10:11], v[12:13]
    v_cvt_pk_bf16_f32 v10, v10, v11
    v_dot2c_f32_bf16 v8, v10, v9
    v_lshlrev_b32 v10, 16, v151
    v_and_b32 v11, 0xffff0000, v151
    v_lshlrev_b32 v12, 16, v87
    v_and_b32 v13, 0xffff0000, v87
    v_pk_mul_f32 v[10:11], v[10:11], v[12:13]
    v_cvt_pk_bf16_f32 v10, v10, v11
    v_dot2c_f32_bf16 v8, v10, v9
    v_lshlrev_b32 v10, 16, v152
    v_and_b32 v11, 0xffff0000, v152
    v_lshlrev_b32 v12, 16, v88
    v_and_b32 v13, 0xffff0000, v88
    v_pk_mul_f32 v[10:11], v[10:11], v[12:13]
    v_cvt_pk_bf16_f32 v10, v10, v11
    v_dot2c_f32_bf16 v8, v10, v9
    v_lshlrev_b32 v10, 16, v153
    v_and_b32 v11, 0xffff0000, v153
    v_lshlrev_b32 v12, 16, v89
    v_and_b32 v13, 0xffff0000, v89
    v_pk_mul_f32 v[10:11], v[10:11], v[12:13]
    v_cvt_pk_bf16_f32 v10, v10, v11
    v_dot2c_f32_bf16 v8, v10, v9
    v_lshlrev_b32 v10, 16, v154
    v_and_b32 v11, 0xffff0000, v154
    v_lshlrev_b32 v12, 16, v90
    v_and_b32 v13, 0xffff0000, v90
    v_pk_mul_f32 v[10:11], v[10:11], v[12:13]
    v_cvt_pk_bf16_f32 v10, v10, v11
    v_dot2c_f32_bf16 v8, v10, v9
    v_lshlrev_b32 v10, 16, v155
    v_and_b32 v11, 0xffff0000, v155
    v_lshlrev_b32 v12, 16, v91
    v_and_b32 v13, 0xffff0000, v91
    v_pk_mul_f32 v[10:11], v[10:11], v[12:13]
    v_cvt_pk_bf16_f32 v10, v10, v11
    v_dot2c_f32_bf16 v8, v10, v9
    s_nop 3
    v_add_f32_dpp v8, v8, v8 quad_perm:[1,0,3,2] row_mask:0xf bank_mask:0xf
    s_nop 1
    v_add_f32_dpp v8, v8, v8 quad_perm:[2,3,0,1] row_mask:0xf bank_mask:0xf
    s_nop 1
    v_add_f32_dpp v8, v8, v8 row_half_mirror row_mask:0xf bank_mask:0xf
    v_cvt_pk_bf16_f32 v8, 0, v8
    v_mul_f32 v8, 0xbfb8aa3b, v8
    v_exp_f32 v8, v8
    s_nop 0
    v_add_f32 v8, 1.0, v8
    v_rcp_f32 v8, v8
    s_nop 0
    v_cvt_pk_bf16_f32 v8, 0, v8
    v_and_b32 v11, 7, v2
    v_cmp_eq_u32 vcc, 0, v11
    s_nop 3
    s_and_saveexec_b64 s[28:29], vcc
    global_store_dword v5, v8, s[14:15] sc1
    s_mov_b64 exec, s[28:29]
    v_add_u32 v5, 32, v5
    v_readfirstlane_b32 s58, v15
    s_nop 3
    s_cmp_lg_u32 s58, 0
    s_cbranch_scc1 L_gate_hasn
    v_mov_b32 v14, 0
    s_mov_b32 s59, 30000
L_nonce_gate:
    global_load_dword v15, v14, s[48:49] sc1
    s_waitcnt vmcnt(0)
    v_readfirstlane_b32 s58, v15
    s_nop 3
    s_cmp_lg_u32 s58, 0
    s_cbranch_scc1 L_nonce_done_gate
    s_sleep 1
    s_sub_u32 s59, s59, 1
    s_cmp_lg_u32 s59, 0
    s_cbranch_scc1 L_nonce_gate
L_nonce_done_gate:
L_gate_hasn:
    s_waitcnt vmcnt(0)
    s_lshl_b32 s28, s20, 2
    s_add_u32 s28, s28, 2176
    s_barrier
    v_mov_b32 v14, s28
    v_mov_b32 v15, s58
    v_cmp_eq_u32 vcc, 0, v0
    s_nop 3
    s_and_saveexec_b64 s[56:57], vcc
    s_cbranch_execz L_pub_gate
    global_store_dword v14, v15, s[52:53] sc0 sc1
L_pub_gate:
    s_mov_b64 exec, s[56:57]
    s_endpgm
L_p2:
    s_getpc_b64 s[62:63]
L_pc_here_p2:
    s_sub_u32 s62, s62, L_pc_here_p2-gated_mix__ssm_conv_s4__glu_gated_bilinear__prompt_kernel
    s_subb_u32 s63, s63, 0
    v_lshlrev_b32 v250, 7, v0
    v_min_u32 v250, L_code_end-gated_mix__ssm_conv_s4__glu_gated_bilinear__prompt_kernel-4, v250
    global_load_dword v251, v250, s[62:63]
    s_sub_u32 s20, s2, 480
    s_load_dwordx2 s[4:5], s[0:1], 96
    s_load_dwordx4 s[48:51], s[0:1], 120
    v_lshrrev_b32 v1, 6, v0
    v_and_b32 v2, 63, v0
    v_readfirstlane_b32 s21, v1
    v_lshlrev_b32 v3, 4, v2
    s_mul_i32 s22, s20, 57344
    s_nop 1
    s_mul_i32 s23, s21, 14336
    s_add_u32 s22, s22, s23
    s_mul_i32 s24, s21, 15360
    s_waitcnt lgkmcnt(0)
    s_mov_b32 s6, 1605632
    s_mov_b32 s7, 0x20000
    s_mov_b32 exec_lo, -1
    s_mov_b32 exec_hi, 0x00ffffff
    s_add_u32 m0, s24, 0
    s_add_u32 s25, s22, 0
    buffer_load_dwordx4 v3, s[4:7], s25 offen lds
    s_add_u32 m0, s24, 960
    s_add_u32 s25, s22, 896
    buffer_load_dwordx4 v3, s[4:7], s25 offen lds
    s_add_u32 m0, s24, 1920
    s_add_u32 s25, s22, 1792
    buffer_load_dwordx4 v3, s[4:7], s25 offen lds
    s_add_u32 m0, s24, 2880
    s_add_u32 s25, s22, 2688
    buffer_load_dwordx4 v3, s[4:7], s25 offen lds
    s_add_u32 m0, s24, 3840
    s_add_u32 s25, s22, 3584
    buffer_load_dwordx4 v3, s[4:7], s25 offen lds
    s_add_u32 m0, s24, 4800
    s_add_u32 s25, s22, 4480
    buffer_load_dwordx4 v3, s[4:7], s25 offen lds
    s_add_u32 m0, s24, 5760
    s_add_u32 s25, s22, 5376
    buffer_load_dwordx4 v3, s[4:7], s25 offen lds
    s_add_u32 m0, s24, 6720
    s_add_u32 s25, s22, 6272
    buffer_load_dwordx4 v3, s[4:7], s25 offen lds
    s_add_u32 m0, s24, 7680
    s_add_u32 s25, s22, 7168
    buffer_load_dwordx4 v3, s[4:7], s25 offen lds
    s_add_u32 m0, s24, 8640
    s_add_u32 s25, s22, 8064
    buffer_load_dwordx4 v3, s[4:7], s25 offen lds
    s_add_u32 m0, s24, 9600
    s_add_u32 s25, s22, 8960
    buffer_load_dwordx4 v3, s[4:7], s25 offen lds
    s_add_u32 m0, s24, 10560
    s_add_u32 s25, s22, 9856
    buffer_load_dwordx4 v3, s[4:7], s25 offen lds
    s_add_u32 m0, s24, 11520
    s_add_u32 s25, s22, 10752
    buffer_load_dwordx4 v3, s[4:7], s25 offen lds
    s_add_u32 m0, s24, 12480
    s_add_u32 s25, s22, 11648
    buffer_load_dwordx4 v3, s[4:7], s25 offen lds
    s_add_u32 m0, s24, 13440
    s_add_u32 s25, s22, 12544
    buffer_load_dwordx4 v3, s[4:7], s25 offen lds
    s_add_u32 m0, s24, 14400
    s_add_u32 s25, s22, 13440
    buffer_load_dwordx4 v3, s[4:7], s25 offen lds
    s_mov_b64 exec, -1
    v_mov_b32 v14, 0
    global_load_dword v15, v14, s[48:49] sc1
    v_lshrrev_b32 v4, 5, v2
    v_bfe_u32 v5, v2, 2, 2
    v_lshl_add_u32 v4, v4, 2, v5
    s_lshl_b32 s26, s21, 4
    v_add_u32 v4, s26, v4
    v_mul_u32_u24 v4, 960, v4
    v_bfe_u32 v5, v2, 4, 1
    v_lshl_add_u32 v4, v5, 5, v4
    v_and_b32 v5, 3, v2
    v_lshl_add_u32 v4, v5, 3, v4
    s_add_u32 s12, s50, 8388608
    s_addc_u32 s13, s51, 0
    s_add_u32 s52, s50, 10092544
    s_addc_u32 s53, s51, 0
    s_lshl_b32 s26, s20, 2
    s_add_u32 s26, s26, s21
    s_lshl_b32 s26, s26, 10
    v_add_u32 v6, s26, v3
    s_waitcnt vmcnt(0)
    ds_read_b64_tr_b16 v[16:17], v4 offset:0
    ds_read_b64_tr_b16 v[18:19], v4 offset:7680
    ds_read_b64_tr_b16 v[20:21], v4 offset:64
    ds_read_b64_tr_b16 v[22:23], v4 offset:7744
    ds_read_b64_tr_b16 v[24:25], v4 offset:128
    ds_read_b64_tr_b16 v[26:27], v4 offset:7808
    ds_read_b64_tr_b16 v[28:29], v4 offset:192
    ds_read_b64_tr_b16 v[30:31], v4 offset:7872
    ds_read_b64_tr_b16 v[32:33], v4 offset:256
    ds_read_b64_tr_b16 v[34:35], v4 offset:7936
    ds_read_b64_tr_b16 v[36:37], v4 offset:320
    ds_read_b64_tr_b16 v[38:39], v4 offset:8000
    ds_read_b64_tr_b16 v[40:41], v4 offset:384
    ds_read_b64_tr_b16 v[42:43], v4 offset:8064
    ds_read_b64_tr_b16 v[44:45], v4 offset:448
    ds_read_b64_tr_b16 v[46:47], v4 offset:8128
    ds_read_b64_tr_b16 v[48:49], v4 offset:512
    ds_read_b64_tr_b16 v[50:51], v4 offset:8192
    ds_read_b64_tr_b16 v[52:53], v4 offset:576
    ds_read_b64_tr_b16 v[54:55], v4 offset:8256
    ds_read_b64_tr_b16 v[56:57], v4 offset:640
    ds_read_b64_tr_b16 v[58:59], v4 offset:8320
    ds_read_b64_tr_b16 v[60:61], v4 offset:704
    ds_read_b64_tr_b16 v[62:63], v4 offset:8384
    ds_read_b64_tr_b16 v[64:65], v4 offset:768
    ds_read_b64_tr_b16 v[66:67], v4 offset:8448
    ds_read_b64_tr_b16 v[68:69], v4 offset:832
    ds_read_b64_tr_b16 v[70:71], v4 offset:8512
    s_waitcnt lgkmcnt(15)
    global_store_dwordx4 v6, v[16:19], s[12:13] sc1
    v_add_u32 v6, 114688, v6
    s_waitcnt lgkmcnt(15)
    global_store_dwordx4 v6, v[20:23], s[12:13] sc1
    v_add_u32 v6, 114688, v6
    s_waitcnt lgkmcnt(15)
    global_store_dwordx4 v6, v[24:27], s[12:13] sc1
    v_add_u32 v6, 114688, v6
    s_waitcnt lgkmcnt(15)
    global_store_dwordx4 v6, v[28:31], s[12:13] sc1
    v_add_u32 v6, 114688, v6
    s_waitcnt lgkmcnt(15)
    global_store_dwordx4 v6, v[32:35], s[12:13] sc1
    v_add_u32 v6, 114688, v6
    s_waitcnt lgkmcnt(15)
    global_store_dwordx4 v6, v[36:39], s[12:13] sc1
    v_add_u32 v6, 114688, v6
    s_waitcnt lgkmcnt(14)
    global_store_dwordx4 v6, v[40:43], s[12:13] sc1
    v_add_u32 v6, 114688, v6
    s_waitcnt lgkmcnt(12)
    global_store_dwordx4 v6, v[44:47], s[12:13] sc1
    v_add_u32 v6, 114688, v6
    s_waitcnt lgkmcnt(10)
    global_store_dwordx4 v6, v[48:51], s[12:13] sc1
    v_add_u32 v6, 114688, v6
    s_waitcnt lgkmcnt(8)
    global_store_dwordx4 v6, v[52:55], s[12:13] sc1
    v_add_u32 v6, 114688, v6
    s_waitcnt lgkmcnt(6)
    global_store_dwordx4 v6, v[56:59], s[12:13] sc1
    v_add_u32 v6, 114688, v6
    s_waitcnt lgkmcnt(4)
    global_store_dwordx4 v6, v[60:63], s[12:13] sc1
    v_add_u32 v6, 114688, v6
    s_waitcnt lgkmcnt(2)
    global_store_dwordx4 v6, v[64:67], s[12:13] sc1
    v_add_u32 v6, 114688, v6
    s_waitcnt lgkmcnt(0)
    global_store_dwordx4 v6, v[68:71], s[12:13] sc1
    v_readfirstlane_b32 s58, v15
    s_nop 3
    s_cmp_lg_u32 s58, 0
    s_cbranch_scc1 L_p2_hasn
    v_mov_b32 v14, 0
    s_mov_b32 s59, 30000
L_nonce_p2:
    global_load_dword v15, v14, s[48:49] sc1
    s_waitcnt vmcnt(0)
    v_readfirstlane_b32 s58, v15
    s_nop 3
    s_cmp_lg_u32 s58, 0
    s_cbranch_scc1 L_nonce_done_p2
    s_sleep 1
    s_sub_u32 s59, s59, 1
    s_cmp_lg_u32 s59, 0
    s_cbranch_scc1 L_nonce_p2
L_nonce_done_p2:
L_p2_hasn:
    s_waitcnt vmcnt(0)
    s_lshl_b32 s28, s20, 2
    s_add_u32 s28, s28, 2048
    s_barrier
    v_mov_b32 v14, s28
    v_mov_b32 v15, s58
    v_cmp_eq_u32 vcc, 0, v0
    s_nop 3
    s_and_saveexec_b64 s[56:57], vcc
    s_cbranch_execz L_pub_p2
    global_store_dword v14, v15, s[52:53] sc0 sc1
L_pub_p2:
    s_mov_b64 exec, s[56:57]
    s_endpgm
L_code_end:
.section .rodata,"a"
.p2align 6
.amdhsa_kernel gated_mix__ssm_conv_s4__glu_gated_bilinear__prompt_kernel
  .amdhsa_next_free_vgpr 256
  .amdhsa_next_free_sgpr 96
  .amdhsa_accum_offset 256
  .amdhsa_group_segment_fixed_size 0
  .amdhsa_kernarg_size 136
  .amdhsa_user_sgpr_count 2
  .amdhsa_user_sgpr_kernarg_segment_ptr 1
  .amdhsa_system_sgpr_workgroup_id_x 1
  .amdhsa_float_denorm_mode_32 3
.end_amdhsa_kernel
```
